```python
import torch

def _softmax(x, axis=-1):
    return torch.softmax(x, dim=axis)
def _gelu(x):
    return torch.nn.functional.gelu(x, approximate="tanh")
def _silu(x):
    return torch.nn.functional.silu(x)
def _sigmoid(x):
    return torch.sigmoid(x)
def _layernorm(x, axis=-1, eps=1e-5):
    m = x.mean(dim=axis, keepdim=True)
    v = x.var(dim=axis, keepdim=True, unbiased=False)
    return (x - m) / torch.sqrt(v + eps)
def _scatter_add(tgt, idx, src, axis=0):
    return tgt.clone().index_add_(axis, idx, src)
def _segment_sum(src, seg, n):
    out = torch.zeros((n,) + src.shape[1:], dtype=src.dtype)
    return out.index_add_(0, seg, src)
def _pad(x, pw):
    flat = tuple(v for pair in reversed(pw) for v in pair)
    return torch.nn.functional.pad(x, flat)

kernel_name = 'parallel_sum__ssm_conv_h3__mixer_token_mlp__prompt'

def setup_inputs():

    _w = (lambda a: (lambda t: t.to(torch.bfloat16) if t.is_floating_point() else t)(torch.as_tensor(a)))
    def _A_setup():
        B, S, D = 1, 2048, 1024
        ks = 4
        return {
            "q": _w((lambda *s: torch.randn(*s, dtype=torch.bfloat16) * 0.05)(B, S, D)),
            "k": _w((lambda *s: torch.randn(*s, dtype=torch.bfloat16) * 0.2)(B, S, D)),
            "v": _w((lambda *s: torch.randn(*s, dtype=torch.bfloat16) * 0.2)(B, S, D)),
            "shift_k": _w((lambda *s: torch.randn(*s, dtype=torch.bfloat16) * 0.2)(D, ks) * 0.5),
            "ssm_k": _w((lambda *s: torch.randn(*s, dtype=torch.bfloat16) * 0.2)(D, S) * (1.0 / S ** 0.5)),
            "ssm_D": _w((lambda *s: torch.randn(*s, dtype=torch.bfloat16) * 0.2)(D)),
        }
    _A_in = _A_setup()

    def _B_setup():
        B, S, D, F = 1, 2048, 1024, 3584
        return {
            "x": _w((lambda *s: torch.randn(*s, dtype=torch.bfloat16) * 0.05)(B, S, D)),
            "w1": _w((lambda *s: torch.randn(*s, dtype=torch.bfloat16) * 0.4)(S, F) * (S ** -0.5)),
            "b1": _w((lambda *s: torch.randn(*s, dtype=torch.bfloat16) * 3.2)(F) * 0.02),
            "w2": _w((lambda *s: torch.randn(*s, dtype=torch.bfloat16) * 0.2)(F, S) * (F ** -0.5)),
            "b2": _w((lambda *s: torch.randn(*s, dtype=torch.bfloat16) * 0.4)(S) * 0.02),
        }
    _B_in = _B_setup()

    return {
        "A_q": _A_in["q"],
        "A_k": _A_in["k"],
        "A_v": _A_in["v"],
        "A_shift_k": _A_in["shift_k"],
        "A_ssm_k": _A_in["ssm_k"],
        "A_ssm_D": _A_in["ssm_D"],
        "B_x": _B_in["x"],
        "B_w1": _B_in["w1"],
        "B_b1": _B_in["b1"],
        "B_w2": _B_in["w2"],
        "B_b2": _B_in["b2"],
    }

def reference(A_q, A_k, A_v, A_shift_k, A_ssm_k, A_ssm_D, B_x, B_w1, B_b1, B_w2, B_b2):
    def _A_ref(q, k, v, shift_k, ssm_k, ssm_D):
        B, S, D = q.shape
        ks = shift_k.shape[-1]
        k_pad = _pad(k, ((0, 0), (ks - 1, 0), (0, 0)))
        k_shift = torch.zeros_like(k)
        for t in range(ks):
            k_shift = k_shift + k_pad[:, t:t + S, :] * shift_k[:, ks - 1 - t][None, None, :]
        kv = k_shift * v
        L = 2 * S
        kv_pad = _pad(kv, ((0, 0), (0, S), (0, 0)))
        kf_pad = _pad(ssm_k, ((0, 0), (0, S)))
        kv_f = (lambda x, axes=(-2,-1): torch.fft.rfft2(x.float(), dim=axes))(kv_pad[:, None, :, :], axes=(1, 2))
        kf_f = (lambda x, axes=(-2,-1): torch.fft.rfft2(x.float(), dim=axes))(kf_pad[:, None, :], axes=(1, 2))
        kf_f = (lambda x, *d: x.permute(*d))(kf_f, 1, 2, 0)
        y_f = kv_f * kf_f[None, :, :, :]
        y = (lambda x, s, axes=(-2,-1): torch.fft.irfft2(x, s=s, dim=axes).to(torch.bfloat16))(y_f, (1, L), axes=(1, 2))[:, 0, :S, :]
        y = y + kv * ssm_D[None, None, :]
        return q * y

    def _B_ref(x, w1, b1, w2, b2):
        B, S, D = x.shape
        h = _layernorm(x, axis=-1)
        u = torch.einsum("bsd,sf->bdf", h, w1) + b1
        u = _gelu(u)
        y = torch.einsum("bdf,fs->bds", u, w2) + b2
        return (lambda x, *d: x.permute(*d))(y, 0, 2, 1)

    x = A_q
    xn = _layernorm(x, axis=-1)
    return x + _A_ref(xn, A_k, A_v, A_shift_k, A_ssm_k, A_ssm_D) + _B_ref(xn, B_w1, B_b1, B_w2, B_b2)
```

```asm
; @launch kernel=prep_kernel grid=(512,1,1) block=(512,1,1) lds=18432
; @launch kernel=gemm1_kernel grid=(256,1,1) block=(768,1,1) lds=152064
; @launch kernel=gemm2_kernel grid=(256,1,1) block=(512,1,1) lds=147456
.amdgcn_target "amdgcn-amd-amdhsa--gfx950"
.text
.globl prep_kernel
.p2align 8
.type prep_kernel,@function
prep_kernel:
    s_load_dwordx4 s[8:11], s[0:1], 8
    s_load_dwordx2 s[12:13], s[0:1], 24
    s_load_dwordx2 s[6:7], s[0:1], 104
    s_load_dwordx2 s[14:15], s[0:1], 32
    s_load_dwordx2 s[40:41], s[0:1], 0
    s_load_dwordx2 s[44:45], s[0:1], 56
    s_cmp_ge_u32 s2, 512
    s_cbranch_scc1 kv_done
    v_mov_b32 v62, v0
    v_lshrrev_b32 v1, 6, v0
    v_and_b32 v0, 63, v0
    s_lshr_b32 s3, s2, 3
    s_and_b32 s3, s3, 1
    v_readfirstlane_b32 s32, v1
    s_lshr_b32 s33, s2, 4
    s_lshl_b32 s33, s33, 3
    s_and_b32 s2, s2, 7
    s_add_u32 s2, s2, s33
    v_mov_b32 v60, 0xffff0000
    s_cmp_eq_u32 s3, 1
    s_cbranch_scc1 prep_ln

    s_lshr_b32 s34, s2, 3
    s_and_b32 s35, s2, 7
    s_lshl_b32 s36, s34, 6
    s_lshl_b32 s38, s35, 7
    s_lshl_b32 s37, s32, 3
    s_add_u32 s36, s36, s37
    v_lshlrev_b32 v1, 1, v0
    v_add_u32 v1, s38, v1
    v_lshlrev_b32 v2, 1, v1
    s_lshl_b32 s39, s36, 11
    v_add_u32 v3, s39, v2
    v_subrev_u32 v4, 6144, v3
    v_lshlrev_b32 v5, 3, v1
    s_waitcnt lgkmcnt(0)

    s_mov_b32 s16, s8
    s_mov_b32 s17, s9
    s_and_b32 s17, s17, 0xffff
    s_mov_b32 s18, 0x400000
    s_mov_b32 s19, 0x20000
    s_mov_b32 s20, s10
    s_mov_b32 s21, s11
    s_and_b32 s21, s21, 0xffff
    s_mov_b32 s22, 0x400000
    s_mov_b32 s23, 0x20000
    s_mov_b32 s24, s12
    s_mov_b32 s25, s13
    s_and_b32 s25, s25, 0xffff
    s_mov_b32 s26, 0x2000
    s_mov_b32 s27, 0x20000
    s_add_u32 s28, s6, 0x400000
    s_addc_u32 s29, s7, 0
    s_and_b32 s29, s29, 0xffff
    s_mov_b32 s30, 0x400000
    s_mov_b32 s31, 0x20000
    s_mov_b32 s48, s14
    s_mov_b32 s49, s15
    s_and_b32 s49, s49, 0xffff
    s_mov_b32 s50, 0x400000
    s_mov_b32 s51, 0x20000
    buffer_load_dwordx4 v[8:11], v5, s[24:27], 0 offen
    v_add_u32 v6, 0, v4
    buffer_load_dword v64, v6, s[16:19], 0 offen
    v_add_u32 v6, 2048, v4
    buffer_load_dword v65, v6, s[16:19], 0 offen
    v_add_u32 v6, 4096, v4
    buffer_load_dword v66, v6, s[16:19], 0 offen
    v_add_u32 v6, 6144, v4
    buffer_load_dword v67, v6, s[16:19], 0 offen
    v_add_u32 v6, 8192, v4
    buffer_load_dword v68, v6, s[16:19], 0 offen
    v_add_u32 v6, 10240, v4
    buffer_load_dword v69, v6, s[16:19], 0 offen
    v_add_u32 v6, 12288, v4
    buffer_load_dword v70, v6, s[16:19], 0 offen
    v_add_u32 v6, 14336, v4
    buffer_load_dword v71, v6, s[16:19], 0 offen
    v_add_u32 v6, 16384, v4
    buffer_load_dword v72, v6, s[16:19], 0 offen
    v_add_u32 v6, 18432, v4
    buffer_load_dword v73, v6, s[16:19], 0 offen
    v_add_u32 v6, 20480, v4
    buffer_load_dword v74, v6, s[16:19], 0 offen
    v_add_u32 v6, 0, v3
    buffer_load_dword v76, v6, s[20:23], 0 offen
    v_add_u32 v6, 2048, v3
    buffer_load_dword v77, v6, s[20:23], 0 offen
    v_add_u32 v6, 4096, v3
    buffer_load_dword v78, v6, s[20:23], 0 offen
    v_add_u32 v6, 6144, v3
    buffer_load_dword v79, v6, s[20:23], 0 offen
    v_add_u32 v6, 8192, v3
    buffer_load_dword v80, v6, s[20:23], 0 offen
    v_add_u32 v6, 10240, v3
    buffer_load_dword v81, v6, s[20:23], 0 offen
    v_add_u32 v6, 12288, v3
    buffer_load_dword v82, v6, s[20:23], 0 offen
    v_add_u32 v6, 14336, v3
    buffer_load_dword v83, v6, s[20:23], 0 offen
    s_lshl_b32 s42, s2, 3
    s_add_u32 s42, s42, s32
    s_lshl_b32 s42, s42, 11
    v_lshlrev_b32 v61, 4, v0
    buffer_load_dwordx4 v[56:59], v61, s[48:51], s42 offen
    buffer_load_dwordx4 v[56:59], v61, s[48:51], s42 offen offset:1024

    s_waitcnt vmcnt(21)
    v_lshlrev_b32 v12, 16, v8
    v_and_b32 v14, v60, v8
    v_lshlrev_b32 v16, 16, v9
    v_and_b32 v18, v60, v9
    v_lshlrev_b32 v13, 16, v10
    v_and_b32 v15, v60, v10
    v_lshlrev_b32 v17, 16, v11
    v_and_b32 v19, v60, v11
    s_waitcnt vmcnt(2)
    v_lshlrev_b32 v20, 16, v64
    v_and_b32 v21, v60, v64
    v_lshlrev_b32 v22, 16, v65
    v_and_b32 v23, v60, v65
    v_lshlrev_b32 v24, 16, v66
    v_and_b32 v25, v60, v66
    v_lshlrev_b32 v26, 16, v67
    v_and_b32 v27, v60, v67
    v_lshlrev_b32 v28, 16, v68
    v_and_b32 v29, v60, v68
    v_pk_mul_f32 v[30:31], v[20:21], v[18:19]
    v_pk_mul_f32 v[36:37], v[22:23], v[18:19]
    v_cvt_pk_bf16_f32 v34, v30, v31
    v_cvt_pk_bf16_f32 v40, v36, v37
    v_lshlrev_b32 v30, 16, v34
    v_lshlrev_b32 v36, 16, v40
    v_and_b32 v31, v60, v34
    v_and_b32 v37, v60, v40
    v_pk_mul_f32 v[32:33], v[22:23], v[16:17]
    v_pk_mul_f32 v[38:39], v[24:25], v[16:17]
    v_cvt_pk_bf16_f32 v34, v32, v33
    v_cvt_pk_bf16_f32 v40, v38, v39
    v_lshlrev_b32 v32, 16, v34
    v_lshlrev_b32 v38, 16, v40
    v_and_b32 v33, v60, v34
    v_and_b32 v39, v60, v40
    v_pk_add_f32 v[30:31], v[30:31], v[32:33]
    v_pk_add_f32 v[36:37], v[36:37], v[38:39]
    v_cvt_pk_bf16_f32 v34, v30, v31
    v_cvt_pk_bf16_f32 v40, v36, v37
    v_lshlrev_b32 v30, 16, v34
    v_lshlrev_b32 v36, 16, v40
    v_and_b32 v31, v60, v34
    v_and_b32 v37, v60, v40
    v_pk_mul_f32 v[32:33], v[24:25], v[14:15]
    v_pk_mul_f32 v[38:39], v[26:27], v[14:15]
    v_cvt_pk_bf16_f32 v34, v32, v33
    v_cvt_pk_bf16_f32 v40, v38, v39
    v_lshlrev_b32 v32, 16, v34
    v_lshlrev_b32 v38, 16, v40
    v_and_b32 v33, v60, v34
    v_and_b32 v39, v60, v40
    v_pk_add_f32 v[30:31], v[30:31], v[32:33]
    v_pk_add_f32 v[36:37], v[36:37], v[38:39]
    v_cvt_pk_bf16_f32 v34, v30, v31
    v_cvt_pk_bf16_f32 v40, v36, v37
    v_lshlrev_b32 v30, 16, v34
    v_lshlrev_b32 v36, 16, v40
    v_and_b32 v31, v60, v34
    v_and_b32 v37, v60, v40
    v_pk_mul_f32 v[32:33], v[26:27], v[12:13]
    v_pk_mul_f32 v[38:39], v[28:29], v[12:13]
    v_cvt_pk_bf16_f32 v34, v32, v33
    v_cvt_pk_bf16_f32 v40, v38, v39
    v_lshlrev_b32 v32, 16, v34
    v_lshlrev_b32 v38, 16, v40
    v_and_b32 v33, v60, v34
    v_and_b32 v39, v60, v40
    v_pk_add_f32 v[30:31], v[30:31], v[32:33]
    v_pk_add_f32 v[36:37], v[36:37], v[38:39]
    v_cvt_pk_bf16_f32 v34, v30, v31
    v_cvt_pk_bf16_f32 v40, v36, v37
    v_lshlrev_b32 v30, 16, v34
    v_lshlrev_b32 v36, 16, v40
    v_and_b32 v31, v60, v34
    v_and_b32 v37, v60, v40
    v_lshlrev_b32 v32, 16, v76
    v_lshlrev_b32 v38, 16, v77
    v_and_b32 v33, v60, v76
    v_and_b32 v39, v60, v77
    v_pk_mul_f32 v[84:85], v[30:31], v[32:33]
    v_pk_mul_f32 v[86:87], v[36:37], v[38:39]
    v_lshlrev_b32 v20, 16, v69
    v_and_b32 v21, v60, v69
    v_lshlrev_b32 v22, 16, v70
    v_and_b32 v23, v60, v70
    v_pk_mul_f32 v[30:31], v[24:25], v[18:19]
    v_pk_mul_f32 v[36:37], v[26:27], v[18:19]
    v_cvt_pk_bf16_f32 v34, v30, v31
    v_cvt_pk_bf16_f32 v40, v36, v37
    v_lshlrev_b32 v30, 16, v34
    v_lshlrev_b32 v36, 16, v40
    v_and_b32 v31, v60, v34
    v_and_b32 v37, v60, v40
    v_pk_mul_f32 v[32:33], v[26:27], v[16:17]
    v_pk_mul_f32 v[38:39], v[28:29], v[16:17]
    v_cvt_pk_bf16_f32 v34, v32, v33
    v_cvt_pk_bf16_f32 v40, v38, v39
    v_lshlrev_b32 v32, 16, v34
    v_lshlrev_b32 v38, 16, v40
    v_and_b32 v33, v60, v34
    v_and_b32 v39, v60, v40
    v_pk_add_f32 v[30:31], v[30:31], v[32:33]
    v_pk_add_f32 v[36:37], v[36:37], v[38:39]
    v_cvt_pk_bf16_f32 v34, v30, v31
    v_cvt_pk_bf16_f32 v40, v36, v37
    v_lshlrev_b32 v30, 16, v34
    v_lshlrev_b32 v36, 16, v40
    v_and_b32 v31, v60, v34
    v_and_b32 v37, v60, v40
    v_pk_mul_f32 v[32:33], v[28:29], v[14:15]
    v_pk_mul_f32 v[38:39], v[20:21], v[14:15]
    v_cvt_pk_bf16_f32 v34, v32, v33
    v_cvt_pk_bf16_f32 v40, v38, v39
    v_lshlrev_b32 v32, 16, v34
    v_lshlrev_b32 v38, 16, v40
    v_and_b32 v33, v60, v34
    v_and_b32 v39, v60, v40
    v_pk_add_f32 v[30:31], v[30:31], v[32:33]
    v_pk_add_f32 v[36:37], v[36:37], v[38:39]
    v_cvt_pk_bf16_f32 v34, v30, v31
    v_cvt_pk_bf16_f32 v40, v36, v37
    v_lshlrev_b32 v30, 16, v34
    v_lshlrev_b32 v36, 16, v40
    v_and_b32 v31, v60, v34
    v_and_b32 v37, v60, v40
    v_pk_mul_f32 v[32:33], v[20:21], v[12:13]
    v_pk_mul_f32 v[38:39], v[22:23], v[12:13]
    v_cvt_pk_bf16_f32 v34, v32, v33
    v_cvt_pk_bf16_f32 v40, v38, v39
    v_lshlrev_b32 v32, 16, v34
    v_lshlrev_b32 v38, 16, v40
    v_and_b32 v33, v60, v34
    v_and_b32 v39, v60, v40
    v_pk_add_f32 v[30:31], v[30:31], v[32:33]
    v_pk_add_f32 v[36:37], v[36:37], v[38:39]
    v_cvt_pk_bf16_f32 v34, v30, v31
    v_cvt_pk_bf16_f32 v40, v36, v37
    v_lshlrev_b32 v30, 16, v34
    v_lshlrev_b32 v36, 16, v40
    v_and_b32 v31, v60, v34
    v_and_b32 v37, v60, v40
    v_lshlrev_b32 v32, 16, v78
    v_lshlrev_b32 v38, 16, v79
    v_and_b32 v33, v60, v78
    v_and_b32 v39, v60, v79
    v_pk_mul_f32 v[88:89], v[30:31], v[32:33]
    v_pk_mul_f32 v[90:91], v[36:37], v[38:39]
    v_lshlrev_b32 v24, 16, v71
    v_and_b32 v25, v60, v71
    v_lshlrev_b32 v26, 16, v72
    v_and_b32 v27, v60, v72
    v_pk_mul_f32 v[30:31], v[28:29], v[18:19]
    v_pk_mul_f32 v[36:37], v[20:21], v[18:19]
    v_cvt_pk_bf16_f32 v34, v30, v31
    v_cvt_pk_bf16_f32 v40, v36, v37
    v_lshlrev_b32 v30, 16, v34
    v_lshlrev_b32 v36, 16, v40
    v_and_b32 v31, v60, v34
    v_and_b32 v37, v60, v40
    v_pk_mul_f32 v[32:33], v[20:21], v[16:17]
    v_pk_mul_f32 v[38:39], v[22:23], v[16:17]
    v_cvt_pk_bf16_f32 v34, v32, v33
    v_cvt_pk_bf16_f32 v40, v38, v39
    v_lshlrev_b32 v32, 16, v34
    v_lshlrev_b32 v38, 16, v40
    v_and_b32 v33, v60, v34
    v_and_b32 v39, v60, v40
    v_pk_add_f32 v[30:31], v[30:31], v[32:33]
    v_pk_add_f32 v[36:37], v[36:37], v[38:39]
    v_cvt_pk_bf16_f32 v34, v30, v31
    v_cvt_pk_bf16_f32 v40, v36, v37
    v_lshlrev_b32 v30, 16, v34
    v_lshlrev_b32 v36, 16, v40
    v_and_b32 v31, v60, v34
    v_and_b32 v37, v60, v40
    v_pk_mul_f32 v[32:33], v[22:23], v[14:15]
    v_pk_mul_f32 v[38:39], v[24:25], v[14:15]
    v_cvt_pk_bf16_f32 v34, v32, v33
    v_cvt_pk_bf16_f32 v40, v38, v39
    v_lshlrev_b32 v32, 16, v34
    v_lshlrev_b32 v38, 16, v40
    v_and_b32 v33, v60, v34
    v_and_b32 v39, v60, v40
    v_pk_add_f32 v[30:31], v[30:31], v[32:33]
    v_pk_add_f32 v[36:37], v[36:37], v[38:39]
    v_cvt_pk_bf16_f32 v34, v30, v31
    v_cvt_pk_bf16_f32 v40, v36, v37
    v_lshlrev_b32 v30, 16, v34
    v_lshlrev_b32 v36, 16, v40
    v_and_b32 v31, v60, v34
    v_and_b32 v37, v60, v40
    v_pk_mul_f32 v[32:33], v[24:25], v[12:13]
    v_pk_mul_f32 v[38:39], v[26:27], v[12:13]
    v_cvt_pk_bf16_f32 v34, v32, v33
    v_cvt_pk_bf16_f32 v40, v38, v39
    v_lshlrev_b32 v32, 16, v34
    v_lshlrev_b32 v38, 16, v40
    v_and_b32 v33, v60, v34
    v_and_b32 v39, v60, v40
    v_pk_add_f32 v[30:31], v[30:31], v[32:33]
    v_pk_add_f32 v[36:37], v[36:37], v[38:39]
    v_cvt_pk_bf16_f32 v34, v30, v31
    v_cvt_pk_bf16_f32 v40, v36, v37
    v_lshlrev_b32 v30, 16, v34
    v_lshlrev_b32 v36, 16, v40
    v_and_b32 v31, v60, v34
    v_and_b32 v37, v60, v40
    v_lshlrev_b32 v32, 16, v80
    v_lshlrev_b32 v38, 16, v81
    v_and_b32 v33, v60, v80
    v_and_b32 v39, v60, v81
    v_pk_mul_f32 v[92:93], v[30:31], v[32:33]
    v_pk_mul_f32 v[94:95], v[36:37], v[38:39]
    v_lshlrev_b32 v28, 16, v73
    v_and_b32 v29, v60, v73
    v_lshlrev_b32 v20, 16, v74
    v_and_b32 v21, v60, v74
    v_pk_mul_f32 v[30:31], v[22:23], v[18:19]
    v_pk_mul_f32 v[36:37], v[24:25], v[18:19]
    v_cvt_pk_bf16_f32 v34, v30, v31
    v_cvt_pk_bf16_f32 v40, v36, v37
    v_lshlrev_b32 v30, 16, v34
    v_lshlrev_b32 v36, 16, v40
    v_and_b32 v31, v60, v34
    v_and_b32 v37, v60, v40
    v_pk_mul_f32 v[32:33], v[24:25], v[16:17]
    v_pk_mul_f32 v[38:39], v[26:27], v[16:17]
    v_cvt_pk_bf16_f32 v34, v32, v33
    v_cvt_pk_bf16_f32 v40, v38, v39
    v_lshlrev_b32 v32, 16, v34
    v_lshlrev_b32 v38, 16, v40
    v_and_b32 v33, v60, v34
    v_and_b32 v39, v60, v40
    v_pk_add_f32 v[30:31], v[30:31], v[32:33]
    v_pk_add_f32 v[36:37], v[36:37], v[38:39]
    v_cvt_pk_bf16_f32 v34, v30, v31
    v_cvt_pk_bf16_f32 v40, v36, v37
    v_lshlrev_b32 v30, 16, v34
    v_lshlrev_b32 v36, 16, v40
    v_and_b32 v31, v60, v34
    v_and_b32 v37, v60, v40
    v_pk_mul_f32 v[32:33], v[26:27], v[14:15]
    v_pk_mul_f32 v[38:39], v[28:29], v[14:15]
    v_cvt_pk_bf16_f32 v34, v32, v33
    v_cvt_pk_bf16_f32 v40, v38, v39
    v_lshlrev_b32 v32, 16, v34
    v_lshlrev_b32 v38, 16, v40
    v_and_b32 v33, v60, v34
    v_and_b32 v39, v60, v40
    v_pk_add_f32 v[30:31], v[30:31], v[32:33]
    v_pk_add_f32 v[36:37], v[36:37], v[38:39]
    v_cvt_pk_bf16_f32 v34, v30, v31
    v_cvt_pk_bf16_f32 v40, v36, v37
    v_lshlrev_b32 v30, 16, v34
    v_lshlrev_b32 v36, 16, v40
    v_and_b32 v31, v60, v34
    v_and_b32 v37, v60, v40
    v_pk_mul_f32 v[32:33], v[28:29], v[12:13]
    v_pk_mul_f32 v[38:39], v[20:21], v[12:13]
    v_cvt_pk_bf16_f32 v34, v32, v33
    v_cvt_pk_bf16_f32 v40, v38, v39
    v_lshlrev_b32 v32, 16, v34
    v_lshlrev_b32 v38, 16, v40
    v_and_b32 v33, v60, v34
    v_and_b32 v39, v60, v40
    v_pk_add_f32 v[30:31], v[30:31], v[32:33]
    v_pk_add_f32 v[36:37], v[36:37], v[38:39]
    v_cvt_pk_bf16_f32 v34, v30, v31
    v_cvt_pk_bf16_f32 v40, v36, v37
    v_lshlrev_b32 v30, 16, v34
    v_lshlrev_b32 v36, 16, v40
    v_and_b32 v31, v60, v34
    v_and_b32 v37, v60, v40
    v_lshlrev_b32 v32, 16, v82
    v_lshlrev_b32 v38, 16, v83
    v_and_b32 v33, v60, v82
    v_and_b32 v39, v60, v83
    v_pk_mul_f32 v[96:97], v[30:31], v[32:33]
    v_pk_mul_f32 v[98:99], v[36:37], v[38:39]
    v_mul_u32_u24 v6, 288, v0
    s_lshl_b32 s40, s32, 4
    v_add_u32 v6, s40, v6

    v_cvt_pk_bf16_f32 v44, v98, v96
    v_cvt_pk_bf16_f32 v45, v94, v92
    v_cvt_pk_bf16_f32 v46, v90, v88
    v_cvt_pk_bf16_f32 v47, v86, v84
    ds_write_b128 v6, v[44:47] offset:0
    v_cvt_pk_bf16_f32 v48, v99, v97
    v_cvt_pk_bf16_f32 v49, v95, v93
    v_cvt_pk_bf16_f32 v50, v91, v89
    v_cvt_pk_bf16_f32 v51, v87, v85
    ds_write_b128 v6, v[48:51] offset:144
    v_lshrrev_b32 v7, 3, v62
    v_and_b32 v8, 7, v62
    v_lshlrev_b32 v8, 4, v8
    v_mul_u32_u24 v9, 144, v7
    v_add_u32 v9, v9, v8
    v_add_u32 v7, s38, v7
    v_lshl_add_u32 v7, v7, 12, v8
    s_lshl_b32 s40, s34, 7
    s_add_u32 s41, s40, 262144
    s_waitcnt lgkmcnt(0)
    s_barrier
    ds_read_b128 v[44:47], v9
    ds_read_b128 v[48:51], v9 offset:9216
    s_waitcnt lgkmcnt(1)
    buffer_store_dwordx4 v[44:47], v7, s[28:31], s40 offen
    s_waitcnt lgkmcnt(0)
    buffer_store_dwordx4 v[48:51], v7, s[28:31], s41 offen

kv_done:
    s_endpgm
prep_ln:
    s_lshl_b32 s33, s2, 3
    s_add_u32 s33, s33, s32
    s_lshl_b32 s34, s33, 11
    v_lshlrev_b32 v2, 4, v0
    v_lshrrev_b32 v3, 4, v0
    v_lshlrev_b32 v3, 14, v3
    v_and_b32 v1, 15, v0
    v_lshl_add_u32 v3, v1, 4, v3
    s_waitcnt lgkmcnt(0)

    s_mov_b32 s16, s40
    s_mov_b32 s17, s41
    s_and_b32 s17, s17, 0xffff
    s_mov_b32 s18, 0x400000
    s_mov_b32 s19, 0x20000
    s_mov_b32 s20, s6
    s_mov_b32 s21, s7
    s_and_b32 s21, s21, 0xffff
    s_mov_b32 s22, 0x400000
    s_mov_b32 s23, 0x20000
    s_add_u32 s24, s6, 0x1400000
    s_addc_u32 s25, s7, 0
    s_and_b32 s25, s25, 0xffff
    s_mov_b32 s26, 0x4000
    s_mov_b32 s27, 0x20000
    buffer_load_dwordx4 v[4:7], v2, s[16:19], s34 offen
    buffer_load_dwordx4 v[8:11], v2, s[16:19], s34 offen offset:1024

    s_mul_i32 s42, s33, 7168
    s_add_u32 s48, s44, s42
    s_addc_u32 s49, s45, 0
    s_and_b32 s49, s49, 0xffff
    s_mov_b32 s50, 0x1c00
    s_mov_b32 s51, 0x20000
    s_cmp_lt_u32 s33, 2048
    s_cselect_b32 s50, s50, 0
    buffer_load_dwordx4 v[64:67], v2, s[48:51], 0 offen offset:0
    buffer_load_dwordx4 v[64:67], v2, s[48:51], 0 offen offset:1024
    buffer_load_dwordx4 v[64:67], v2, s[48:51], 0 offen offset:2048
    buffer_load_dwordx4 v[64:67], v2, s[48:51], 0 offen offset:3072
    v_add_u32 v12, 4096, v2
    buffer_load_dwordx4 v[64:67], v12, s[48:51], 0 offen offset:0
    buffer_load_dwordx4 v[64:67], v12, s[48:51], 0 offen offset:1024
    buffer_load_dwordx4 v[64:67], v12, s[48:51], 0 offen offset:2048
    s_waitcnt vmcnt(7)
    v_lshlrev_b32 v20, 16, v4
    v_and_b32 v21, v60, v4
    v_lshlrev_b32 v22, 16, v5
    v_and_b32 v23, v60, v5
    v_lshlrev_b32 v24, 16, v6
    v_and_b32 v25, v60, v6
    v_lshlrev_b32 v26, 16, v7
    v_and_b32 v27, v60, v7
    v_lshlrev_b32 v28, 16, v8
    v_and_b32 v29, v60, v8
    v_lshlrev_b32 v30, 16, v9
    v_and_b32 v31, v60, v9
    v_lshlrev_b32 v32, 16, v10
    v_and_b32 v33, v60, v10
    v_lshlrev_b32 v34, 16, v11
    v_and_b32 v35, v60, v11
    v_pk_add_f32 v[36:37], v[20:21], v[22:23]
    v_pk_add_f32 v[38:39], v[24:25], v[26:27]
    v_pk_add_f32 v[36:37], v[36:37], v[28:29]
    v_pk_add_f32 v[38:39], v[38:39], v[30:31]
    v_pk_add_f32 v[36:37], v[36:37], v[32:33]
    v_pk_add_f32 v[38:39], v[38:39], v[34:35]
    v_pk_add_f32 v[36:37], v[36:37], v[38:39]
    v_add_f32 v36, v36, v37
    s_nop 1
    v_add_f32_dpp v36, v36, v36 row_shr:1 row_mask:0xf bank_mask:0xf bound_ctrl:0
    s_nop 1
    v_add_f32_dpp v36, v36, v36 row_shr:2 row_mask:0xf bank_mask:0xf bound_ctrl:0
    s_nop 1
    v_add_f32_dpp v36, v36, v36 row_shr:4 row_mask:0xf bank_mask:0xf bound_ctrl:0
    s_nop 1
    v_add_f32_dpp v36, v36, v36 row_shr:8 row_mask:0xf bank_mask:0xf bound_ctrl:0
    s_nop 1
    v_add_f32_dpp v36, v36, v36 row_bcast:15 row_mask:0xa bank_mask:0xf
    s_nop 1
    v_add_f32_dpp v36, v36, v36 row_bcast:31 row_mask:0xc bank_mask:0xf
    s_nop 1
    v_readlane_b32 s36, v36, 63
    s_nop 1
    v_mov_b32 v48, 0x3a800000
    v_mul_f32 v48, s36, v48
    v_mov_b32 v49, v48
    v_mov_b32 v50, 0
    v_mov_b32 v51, 0
    v_pk_add_f32 v[38:39], v[20:21], v[48:49] neg_lo:[0,1] neg_hi:[0,1]
    v_pk_fma_f32 v[50:51], v[38:39], v[38:39], v[50:51]
    v_pk_add_f32 v[38:39], v[22:23], v[48:49] neg_lo:[0,1] neg_hi:[0,1]
    v_pk_fma_f32 v[50:51], v[38:39], v[38:39], v[50:51]
    v_pk_add_f32 v[38:39], v[24:25], v[48:49] neg_lo:[0,1] neg_hi:[0,1]
    v_pk_fma_f32 v[50:51], v[38:39], v[38:39], v[50:51]
    v_pk_add_f32 v[38:39], v[26:27], v[48:49] neg_lo:[0,1] neg_hi:[0,1]
    v_pk_fma_f32 v[50:51], v[38:39], v[38:39], v[50:51]
    v_pk_add_f32 v[38:39], v[28:29], v[48:49] neg_lo:[0,1] neg_hi:[0,1]
    v_pk_fma_f32 v[50:51], v[38:39], v[38:39], v[50:51]
    v_pk_add_f32 v[38:39], v[30:31], v[48:49] neg_lo:[0,1] neg_hi:[0,1]
    v_pk_fma_f32 v[50:51], v[38:39], v[38:39], v[50:51]
    v_pk_add_f32 v[38:39], v[32:33], v[48:49] neg_lo:[0,1] neg_hi:[0,1]
    v_pk_fma_f32 v[50:51], v[38:39], v[38:39], v[50:51]
    v_pk_add_f32 v[38:39], v[34:35], v[48:49] neg_lo:[0,1] neg_hi:[0,1]
    v_pk_fma_f32 v[50:51], v[38:39], v[38:39], v[50:51]
    v_add_f32 v50, v50, v51
    s_nop 1
    v_add_f32_dpp v50, v50, v50 row_shr:1 row_mask:0xf bank_mask:0xf bound_ctrl:0
    s_nop 1
    v_add_f32_dpp v50, v50, v50 row_shr:2 row_mask:0xf bank_mask:0xf bound_ctrl:0
    s_nop 1
    v_add_f32_dpp v50, v50, v50 row_shr:4 row_mask:0xf bank_mask:0xf bound_ctrl:0
    s_nop 1
    v_add_f32_dpp v50, v50, v50 row_shr:8 row_mask:0xf bank_mask:0xf bound_ctrl:0
    s_nop 1
    v_add_f32_dpp v50, v50, v50 row_bcast:15 row_mask:0xa bank_mask:0xf
    s_nop 1
    v_add_f32_dpp v50, v50, v50 row_bcast:31 row_mask:0xc bank_mask:0xf
    s_nop 1
    v_readlane_b32 s37, v50, 63
    s_nop 1
    v_mov_b32 v54, 0x3a800000
    v_mul_f32 v54, s37, v54
    v_mov_b32 v52, v48
    v_cvt_pk_bf16_f32 v52, v52, v52
    v_lshlrev_b32 v52, 16, v52
    v_cvt_pk_bf16_f32 v54, v54, v54
    v_lshlrev_b32 v54, 16, v54
    v_add_f32 v54, 0x3727c5ac, v54
    v_cvt_pk_bf16_f32 v54, v54, v54
    v_lshlrev_b32 v54, 16, v54
    v_sqrt_f32 v54, v54
    v_mov_b32 v53, v52
    v_cvt_pk_bf16_f32 v54, v54, v54
    v_lshlrev_b32 v54, 16, v54
    v_rcp_f32 v56, v54
    v_rcp_f32 v57, v54
    v_pk_add_f32 v[20:21], v[20:21], v[52:53] neg_lo:[0,1] neg_hi:[0,1]
    v_pk_add_f32 v[22:23], v[22:23], v[52:53] neg_lo:[0,1] neg_hi:[0,1]
    v_pk_add_f32 v[24:25], v[24:25], v[52:53] neg_lo:[0,1] neg_hi:[0,1]
    v_pk_add_f32 v[26:27], v[26:27], v[52:53] neg_lo:[0,1] neg_hi:[0,1]
    v_pk_add_f32 v[28:29], v[28:29], v[52:53] neg_lo:[0,1] neg_hi:[0,1]
    v_pk_add_f32 v[30:31], v[30:31], v[52:53] neg_lo:[0,1] neg_hi:[0,1]
    v_pk_add_f32 v[32:33], v[32:33], v[52:53] neg_lo:[0,1] neg_hi:[0,1]
    v_pk_add_f32 v[34:35], v[34:35], v[52:53] neg_lo:[0,1] neg_hi:[0,1]
    v_cvt_pk_bf16_f32 v40, v20, v21
    v_cvt_pk_bf16_f32 v41, v22, v23
    v_cvt_pk_bf16_f32 v42, v24, v25
    v_cvt_pk_bf16_f32 v43, v26, v27
    v_cvt_pk_bf16_f32 v44, v28, v29
    v_cvt_pk_bf16_f32 v45, v30, v31
    v_cvt_pk_bf16_f32 v46, v32, v33
    v_cvt_pk_bf16_f32 v47, v34, v35
    v_lshlrev_b32 v20, 16, v40
    v_and_b32 v21, v60, v40
    v_lshlrev_b32 v22, 16, v41
    v_and_b32 v23, v60, v41
    v_lshlrev_b32 v24, 16, v42
    v_and_b32 v25, v60, v42
    v_lshlrev_b32 v26, 16, v43
    v_and_b32 v27, v60, v43
    v_lshlrev_b32 v28, 16, v44
    v_and_b32 v29, v60, v44
    v_lshlrev_b32 v30, 16, v45
    v_and_b32 v31, v60, v45
    v_lshlrev_b32 v32, 16, v46
    v_and_b32 v33, v60, v46
    v_lshlrev_b32 v34, 16, v47
    v_and_b32 v35, v60, v47
    v_pk_mul_f32 v[20:21], v[20:21], v[56:57]
    v_pk_mul_f32 v[22:23], v[22:23], v[56:57]
    v_pk_mul_f32 v[24:25], v[24:25], v[56:57]
    v_pk_mul_f32 v[26:27], v[26:27], v[56:57]
    v_pk_mul_f32 v[28:29], v[28:29], v[56:57]
    v_pk_mul_f32 v[30:31], v[30:31], v[56:57]
    v_pk_mul_f32 v[32:33], v[32:33], v[56:57]
    v_pk_mul_f32 v[34:35], v[34:35], v[56:57]
    v_cvt_pk_bf16_f32 v40, v20, v21
    v_cvt_pk_bf16_f32 v41, v22, v23
    v_cvt_pk_bf16_f32 v42, v24, v25
    v_cvt_pk_bf16_f32 v43, v26, v27
    v_cvt_pk_bf16_f32 v44, v28, v29
    v_cvt_pk_bf16_f32 v45, v30, v31
    v_cvt_pk_bf16_f32 v46, v32, v33
    v_cvt_pk_bf16_f32 v47, v34, v35
    s_lshl_b32 s38, s33, 3
    v_mov_b32 v58, v52
    v_mov_b32 v59, v54
    v_mov_b32 v14, 0
    buffer_store_dwordx2 v[58:59], v14, s[24:27], s38 offen

    v_lshlrev_b32 v20, 16, v40
    v_and_b32 v21, v60, v40
    v_lshlrev_b32 v22, 16, v41
    v_and_b32 v23, v60, v41
    v_lshlrev_b32 v24, 16, v42
    v_and_b32 v25, v60, v42
    v_lshlrev_b32 v26, 16, v43
    v_and_b32 v27, v60, v43
    v_lshlrev_b32 v28, 16, v44
    v_and_b32 v29, v60, v44
    v_lshlrev_b32 v30, 16, v45
    v_and_b32 v31, v60, v45
    v_lshlrev_b32 v32, 16, v46
    v_and_b32 v33, v60, v46
    v_lshlrev_b32 v34, 16, v47
    v_and_b32 v35, v60, v47
    v_pk_add_f32 v[36:37], v[20:21], v[22:23]
    v_pk_add_f32 v[38:39], v[24:25], v[26:27]
    v_pk_add_f32 v[36:37], v[36:37], v[28:29]
    v_pk_add_f32 v[38:39], v[38:39], v[30:31]
    v_pk_add_f32 v[36:37], v[36:37], v[32:33]
    v_pk_add_f32 v[38:39], v[38:39], v[34:35]
    v_pk_add_f32 v[36:37], v[36:37], v[38:39]
    v_add_f32 v36, v36, v37
    s_nop 1
    v_add_f32_dpp v36, v36, v36 row_shr:1 row_mask:0xf bank_mask:0xf bound_ctrl:0
    s_nop 1
    v_add_f32_dpp v36, v36, v36 row_shr:2 row_mask:0xf bank_mask:0xf bound_ctrl:0
    s_nop 1
    v_add_f32_dpp v36, v36, v36 row_shr:4 row_mask:0xf bank_mask:0xf bound_ctrl:0
    s_nop 1
    v_add_f32_dpp v36, v36, v36 row_shr:8 row_mask:0xf bank_mask:0xf bound_ctrl:0
    s_nop 1
    v_add_f32_dpp v36, v36, v36 row_bcast:15 row_mask:0xa bank_mask:0xf
    s_nop 1
    v_add_f32_dpp v36, v36, v36 row_bcast:31 row_mask:0xc bank_mask:0xf
    s_nop 1
    v_readlane_b32 s36, v36, 63
    s_nop 1
    v_mov_b32 v48, 0x3a800000
    v_mul_f32 v48, s36, v48
    v_mov_b32 v49, v48
    v_mov_b32 v50, 0
    v_mov_b32 v51, 0
    v_pk_add_f32 v[38:39], v[20:21], v[48:49] neg_lo:[0,1] neg_hi:[0,1]
    v_pk_fma_f32 v[50:51], v[38:39], v[38:39], v[50:51]
    v_pk_add_f32 v[38:39], v[22:23], v[48:49] neg_lo:[0,1] neg_hi:[0,1]
    v_pk_fma_f32 v[50:51], v[38:39], v[38:39], v[50:51]
    v_pk_add_f32 v[38:39], v[24:25], v[48:49] neg_lo:[0,1] neg_hi:[0,1]
    v_pk_fma_f32 v[50:51], v[38:39], v[38:39], v[50:51]
    v_pk_add_f32 v[38:39], v[26:27], v[48:49] neg_lo:[0,1] neg_hi:[0,1]
    v_pk_fma_f32 v[50:51], v[38:39], v[38:39], v[50:51]
    v_pk_add_f32 v[38:39], v[28:29], v[48:49] neg_lo:[0,1] neg_hi:[0,1]
    v_pk_fma_f32 v[50:51], v[38:39], v[38:39], v[50:51]
    v_pk_add_f32 v[38:39], v[30:31], v[48:49] neg_lo:[0,1] neg_hi:[0,1]
    v_pk_fma_f32 v[50:51], v[38:39], v[38:39], v[50:51]
    v_pk_add_f32 v[38:39], v[32:33], v[48:49] neg_lo:[0,1] neg_hi:[0,1]
    v_pk_fma_f32 v[50:51], v[38:39], v[38:39], v[50:51]
    v_pk_add_f32 v[38:39], v[34:35], v[48:49] neg_lo:[0,1] neg_hi:[0,1]
    v_pk_fma_f32 v[50:51], v[38:39], v[38:39], v[50:51]
    v_add_f32 v50, v50, v51
    s_nop 1
    v_add_f32_dpp v50, v50, v50 row_shr:1 row_mask:0xf bank_mask:0xf bound_ctrl:0
    s_nop 1
    v_add_f32_dpp v50, v50, v50 row_shr:2 row_mask:0xf bank_mask:0xf bound_ctrl:0
    s_nop 1
    v_add_f32_dpp v50, v50, v50 row_shr:4 row_mask:0xf bank_mask:0xf bound_ctrl:0
    s_nop 1
    v_add_f32_dpp v50, v50, v50 row_shr:8 row_mask:0xf bank_mask:0xf bound_ctrl:0
    s_nop 1
    v_add_f32_dpp v50, v50, v50 row_bcast:15 row_mask:0xa bank_mask:0xf
    s_nop 1
    v_add_f32_dpp v50, v50, v50 row_bcast:31 row_mask:0xc bank_mask:0xf
    s_nop 1
    v_readlane_b32 s37, v50, 63
    s_nop 1
    v_mov_b32 v54, 0x3a800000
    v_mul_f32 v54, s37, v54
    v_mov_b32 v52, v48
    v_cvt_pk_bf16_f32 v52, v52, v52
    v_lshlrev_b32 v52, 16, v52
    v_cvt_pk_bf16_f32 v54, v54, v54
    v_lshlrev_b32 v54, 16, v54
    v_add_f32 v54, 0x3727c5ac, v54
    v_cvt_pk_bf16_f32 v54, v54, v54
    v_lshlrev_b32 v54, 16, v54
    v_sqrt_f32 v54, v54
    v_mov_b32 v53, v52
    v_cvt_pk_bf16_f32 v54, v54, v54
    v_lshlrev_b32 v54, 16, v54
    v_rcp_f32 v56, v54
    v_rcp_f32 v57, v54
    v_pk_add_f32 v[20:21], v[20:21], v[52:53] neg_lo:[0,1] neg_hi:[0,1]
    v_pk_add_f32 v[22:23], v[22:23], v[52:53] neg_lo:[0,1] neg_hi:[0,1]
    v_pk_add_f32 v[24:25], v[24:25], v[52:53] neg_lo:[0,1] neg_hi:[0,1]
    v_pk_add_f32 v[26:27], v[26:27], v[52:53] neg_lo:[0,1] neg_hi:[0,1]
    v_pk_add_f32 v[28:29], v[28:29], v[52:53] neg_lo:[0,1] neg_hi:[0,1]
    v_pk_add_f32 v[30:31], v[30:31], v[52:53] neg_lo:[0,1] neg_hi:[0,1]
    v_pk_add_f32 v[32:33], v[32:33], v[52:53] neg_lo:[0,1] neg_hi:[0,1]
    v_pk_add_f32 v[34:35], v[34:35], v[52:53] neg_lo:[0,1] neg_hi:[0,1]
    v_cvt_pk_bf16_f32 v40, v20, v21
    v_cvt_pk_bf16_f32 v41, v22, v23
    v_cvt_pk_bf16_f32 v42, v24, v25
    v_cvt_pk_bf16_f32 v43, v26, v27
    v_cvt_pk_bf16_f32 v44, v28, v29
    v_cvt_pk_bf16_f32 v45, v30, v31
    v_cvt_pk_bf16_f32 v46, v32, v33
    v_cvt_pk_bf16_f32 v47, v34, v35
    v_lshlrev_b32 v20, 16, v40
    v_and_b32 v21, v60, v40
    v_lshlrev_b32 v22, 16, v41
    v_and_b32 v23, v60, v41
    v_lshlrev_b32 v24, 16, v42
    v_and_b32 v25, v60, v42
    v_lshlrev_b32 v26, 16, v43
    v_and_b32 v27, v60, v43
    v_lshlrev_b32 v28, 16, v44
    v_and_b32 v29, v60, v44
    v_lshlrev_b32 v30, 16, v45
    v_and_b32 v31, v60, v45
    v_lshlrev_b32 v32, 16, v46
    v_and_b32 v33, v60, v46
    v_lshlrev_b32 v34, 16, v47
    v_and_b32 v35, v60, v47
    v_pk_mul_f32 v[20:21], v[20:21], v[56:57]
    v_pk_mul_f32 v[22:23], v[22:23], v[56:57]
    v_pk_mul_f32 v[24:25], v[24:25], v[56:57]
    v_pk_mul_f32 v[26:27], v[26:27], v[56:57]
    v_pk_mul_f32 v[28:29], v[28:29], v[56:57]
    v_pk_mul_f32 v[30:31], v[30:31], v[56:57]
    v_pk_mul_f32 v[32:33], v[32:33], v[56:57]
    v_pk_mul_f32 v[34:35], v[34:35], v[56:57]
    v_cvt_pk_bf16_f32 v40, v20, v21
    v_cvt_pk_bf16_f32 v41, v22, v23
    v_cvt_pk_bf16_f32 v42, v24, v25
    v_cvt_pk_bf16_f32 v43, v26, v27
    v_cvt_pk_bf16_f32 v44, v28, v29
    v_cvt_pk_bf16_f32 v45, v30, v31
    v_cvt_pk_bf16_f32 v46, v32, v33
    v_cvt_pk_bf16_f32 v47, v34, v35
    s_lshr_b32 s39, s33, 6
    s_lshl_b32 s39, s39, 17
    s_and_b32 s38, s33, 63
    s_lshl_b32 s38, s38, 8
    s_add_u32 s38, s38, s39
    s_add_u32 s39, s38, 65536
    buffer_store_dwordx4 v[40:43], v3, s[20:23], s38 offen
    buffer_store_dwordx4 v[44:47], v3, s[20:23], s39 offen

    s_endpgm
.globl gemm1_kernel
.p2align 8
.type gemm1_kernel,@function
gemm1_kernel:
    s_load_dwordx2 s[4:5], s[0:1], 104
    s_load_dwordx4 s[8:11], s[0:1], 56
    s_cmp_ge_u32 s2, 256
    s_cbranch_scc1 gemm1_kernel_done
    v_lshrrev_b32 v1, 6, v0
    v_and_b32 v0, 63, v0
    s_and_b32 s33, s2, 7
    v_readfirstlane_b32 s31, v1
    s_lshr_b32 s34, s2, 3
    s_and_b32 s35, s33, 1
    s_lshl_b32 s35, s35, 2
    s_and_b32 s36, s34, 3
    s_add_u32 s35, s35, s36
    s_lshr_b32 s36, s33, 1
    s_mul_i32 s36, s36, 7
    s_lshr_b32 s37, s34, 2
    s_add_u32 s36, s36, s37
    s_lshl_b32 s35, s35, 7
    s_mul_i32 s36, s36, 128
    s_and_b32 s32, s31, 3
    v_lshrrev_b32 v2, 4, v0
    v_and_b32 v3, 15, v0
    s_cmp_ge_u32 s31, 8
    s_cbranch_scc1 gemm1_kernel_conv
    s_cmp_ge_u32 s34, 28
    s_cbranch_scc1 gemm1_kernel_helper
    s_cmp_lt_u32 s31, 4
    s_cbranch_scc1 gemm1_kernel_compute

    s_lshl_b32 s40, s32, 4
    s_lshl_b32 s41, s35, 7
    s_lshl_b32 s42, s36, 1
    v_add_u32 v4, s40, v2

    v_add_u32 v5, 0, v2
    v_and_b32 v5, 7, v5
    v_lshlrev_b32 v5, 1, v5
    v_xor_b32 v5, v5, v3
    v_lshlrev_b32 v6, 8, v4
    v_lshl_add_u32 v6, v5, 4, v6
    v_add_u32 v10, s41, v6

    v_add_u32 v5, 4, v2
    v_and_b32 v5, 7, v5
    v_lshlrev_b32 v5, 1, v5
    v_xor_b32 v5, v5, v3
    v_lshlrev_b32 v6, 8, v4
    v_lshl_add_u32 v6, v5, 4, v6
    v_add_u32 v11, s41, v6

    v_add_u32 v5, 8, v2
    v_and_b32 v5, 7, v5
    v_lshlrev_b32 v5, 1, v5
    v_xor_b32 v5, v5, v3
    v_lshlrev_b32 v6, 8, v4
    v_lshl_add_u32 v6, v5, 4, v6
    v_add_u32 v12, s41, v6

    v_add_u32 v5, 12, v2
    v_and_b32 v5, 7, v5
    v_lshlrev_b32 v5, 1, v5
    v_xor_b32 v5, v5, v3
    v_lshlrev_b32 v6, 8, v4
    v_lshl_add_u32 v6, v5, 4, v6
    v_add_u32 v13, s41, v6

    s_lshl_b32 s47, s32, 12
    s_add_u32 s47, s47, 16384
    s_movk_i32 s45, 7168
    v_mul_lo_u32 v7, v4, s45
    v_add_u32 v7, s42, v7

    v_add_u32 v5, 0, v2
    v_and_b32 v5, 7, v5
    v_lshlrev_b32 v5, 1, v5
    v_xor_b32 v5, v5, v3
    v_lshl_add_u32 v6, v5, 4, v7
    v_add_u32 v14, 0, v6

    v_add_u32 v5, 4, v2
    v_and_b32 v5, 7, v5
    v_lshlrev_b32 v5, 1, v5
    v_xor_b32 v5, v5, v3
    v_lshl_add_u32 v6, v5, 4, v7
    v_add_u32 v15, 27648, v6

    v_add_u32 v5, 8, v2
    v_and_b32 v5, 7, v5
    v_lshlrev_b32 v5, 1, v5
    v_xor_b32 v5, v5, v3
    v_lshl_add_u32 v6, v5, 4, v7
    v_add_u32 v16, 55296, v6

    v_add_u32 v5, 12, v2
    v_and_b32 v5, 7, v5
    v_lshlrev_b32 v5, 1, v5
    v_xor_b32 v5, v5, v3
    v_lshl_add_u32 v6, v5, 4, v7
    v_add_u32 v17, 82944, v6

    s_lshl_b32 s46, s32, 12
    s_mov_b32 s48, 0
    s_mov_b32 s49, 0
    s_waitcnt lgkmcnt(0)

    s_mov_b32 s16, s4
    s_mov_b32 s17, s5
    s_and_b32 s17, s17, 0xffff
    s_mov_b32 s18, 0x400000
    s_mov_b32 s19, 0x20000
    s_mov_b32 s20, s8
    s_mov_b32 s21, s9
    s_and_b32 s21, s21, 0xffff
    s_mov_b32 s22, 0xe00000
    s_mov_b32 s23, 0x20000
    s_add_u32 m0, s46, 0
    s_nop 0
    buffer_load_dwordx4 v10, s[16:19], s48 offen offset:0 lds
    buffer_load_dwordx4 v11, s[16:19], s48 offen offset:1024 lds
    buffer_load_dwordx4 v12, s[16:19], s48 offen offset:2048 lds
    buffer_load_dwordx4 v13, s[16:19], s48 offen offset:3072 lds
    s_add_u32 m0, s47, 0
    s_nop 0
    buffer_load_dwordx4 v14, s[20:23], s49 offen offset:0 lds
    buffer_load_dwordx4 v15, s[20:23], s49 offen offset:1024 lds
    buffer_load_dwordx4 v16, s[20:23], s49 offen offset:2048 lds
    buffer_load_dwordx4 v17, s[20:23], s49 offen offset:3072 lds
    s_add_u32 s48, s48, 131072
    s_add_u32 s49, s49, 458752
    s_add_u32 m0, s46, 32768
    s_nop 0
    buffer_load_dwordx4 v10, s[16:19], s48 offen offset:0 lds
    buffer_load_dwordx4 v11, s[16:19], s48 offen offset:1024 lds
    buffer_load_dwordx4 v12, s[16:19], s48 offen offset:2048 lds
    buffer_load_dwordx4 v13, s[16:19], s48 offen offset:3072 lds
    s_add_u32 m0, s47, 32768
    s_nop 0
    buffer_load_dwordx4 v14, s[20:23], s49 offen offset:0 lds
    buffer_load_dwordx4 v15, s[20:23], s49 offen offset:1024 lds
    buffer_load_dwordx4 v16, s[20:23], s49 offen offset:2048 lds
    buffer_load_dwordx4 v17, s[20:23], s49 offen offset:3072 lds
    s_add_u32 s48, s48, 131072
    s_add_u32 s49, s49, 458752
    s_waitcnt vmcnt(8)
    s_barrier
    s_add_u32 m0, s46, 65536
    s_nop 0
    buffer_load_dwordx4 v10, s[16:19], s48 offen offset:0 lds
    buffer_load_dwordx4 v11, s[16:19], s48 offen offset:1024 lds
    buffer_load_dwordx4 v12, s[16:19], s48 offen offset:2048 lds
    buffer_load_dwordx4 v13, s[16:19], s48 offen offset:3072 lds
    s_add_u32 m0, s47, 65536
    s_nop 0
    buffer_load_dwordx4 v14, s[20:23], s49 offen offset:0 lds
    buffer_load_dwordx4 v15, s[20:23], s49 offen offset:1024 lds
    buffer_load_dwordx4 v16, s[20:23], s49 offen offset:2048 lds
    buffer_load_dwordx4 v17, s[20:23], s49 offen offset:3072 lds
    s_add_u32 s48, s48, 131072
    s_add_u32 s49, s49, 458752
    s_mov_b32 s50, 9
gemm1_kernel_lloopa:
    s_waitcnt vmcnt(8)
    s_barrier
    s_add_u32 m0, s46, 0
    s_nop 0
    buffer_load_dwordx4 v10, s[16:19], s48 offen offset:0 lds
    buffer_load_dwordx4 v11, s[16:19], s48 offen offset:1024 lds
    buffer_load_dwordx4 v12, s[16:19], s48 offen offset:2048 lds
    buffer_load_dwordx4 v13, s[16:19], s48 offen offset:3072 lds
    s_add_u32 m0, s47, 0
    s_nop 0
    buffer_load_dwordx4 v14, s[20:23], s49 offen offset:0 lds
    buffer_load_dwordx4 v15, s[20:23], s49 offen offset:1024 lds
    buffer_load_dwordx4 v16, s[20:23], s49 offen offset:2048 lds
    buffer_load_dwordx4 v17, s[20:23], s49 offen offset:3072 lds
    s_add_u32 s48, s48, 131072
    s_add_u32 s49, s49, 458752
    s_waitcnt vmcnt(8)
    s_barrier
    s_add_u32 m0, s46, 32768
    s_nop 0
    buffer_load_dwordx4 v10, s[16:19], s48 offen offset:0 lds
    buffer_load_dwordx4 v11, s[16:19], s48 offen offset:1024 lds
    buffer_load_dwordx4 v12, s[16:19], s48 offen offset:2048 lds
    buffer_load_dwordx4 v13, s[16:19], s48 offen offset:3072 lds
    s_add_u32 m0, s47, 32768
    s_nop 0
    buffer_load_dwordx4 v14, s[20:23], s49 offen offset:0 lds
    buffer_load_dwordx4 v15, s[20:23], s49 offen offset:1024 lds
    buffer_load_dwordx4 v16, s[20:23], s49 offen offset:2048 lds
    buffer_load_dwordx4 v17, s[20:23], s49 offen offset:3072 lds
    s_add_u32 s48, s48, 131072
    s_add_u32 s49, s49, 458752
    s_waitcnt vmcnt(8)
    s_barrier
    s_add_u32 m0, s46, 65536
    s_nop 0
    buffer_load_dwordx4 v10, s[16:19], s48 offen offset:0 lds
    buffer_load_dwordx4 v11, s[16:19], s48 offen offset:1024 lds
    buffer_load_dwordx4 v12, s[16:19], s48 offen offset:2048 lds
    buffer_load_dwordx4 v13, s[16:19], s48 offen offset:3072 lds
    s_add_u32 m0, s47, 65536
    s_nop 0
    buffer_load_dwordx4 v14, s[20:23], s49 offen offset:0 lds
    buffer_load_dwordx4 v15, s[20:23], s49 offen offset:1024 lds
    buffer_load_dwordx4 v16, s[20:23], s49 offen offset:2048 lds
    buffer_load_dwordx4 v17, s[20:23], s49 offen offset:3072 lds
    s_add_u32 s48, s48, 131072
    s_add_u32 s49, s49, 458752
    s_sub_u32 s50, s50, 1
    s_cmp_lg_u32 s50, 0
    s_cbranch_scc1 gemm1_kernel_lloopa

    s_waitcnt vmcnt(8)
    s_barrier
    s_add_u32 m0, s46, 0
    s_nop 0
    buffer_load_dwordx4 v10, s[16:19], s48 offen offset:0 lds
    buffer_load_dwordx4 v11, s[16:19], s48 offen offset:1024 lds
    buffer_load_dwordx4 v12, s[16:19], s48 offen offset:2048 lds
    buffer_load_dwordx4 v13, s[16:19], s48 offen offset:3072 lds
    s_add_u32 m0, s47, 0
    s_nop 0
    buffer_load_dwordx4 v14, s[20:23], s49 offen offset:0 lds
    buffer_load_dwordx4 v15, s[20:23], s49 offen offset:1024 lds
    buffer_load_dwordx4 v16, s[20:23], s49 offen offset:2048 lds
    buffer_load_dwordx4 v17, s[20:23], s49 offen offset:3072 lds
    s_add_u32 s48, s48, 131072
    s_add_u32 s49, s49, 458752
    s_waitcnt vmcnt(8)
    s_barrier
    s_add_u32 m0, s46, 32768
    s_nop 0
    buffer_load_dwordx4 v10, s[16:19], s48 offen offset:0 lds
    buffer_load_dwordx4 v11, s[16:19], s48 offen offset:1024 lds
    buffer_load_dwordx4 v12, s[16:19], s48 offen offset:2048 lds
    buffer_load_dwordx4 v13, s[16:19], s48 offen offset:3072 lds
    s_add_u32 m0, s47, 32768
    s_nop 0
    buffer_load_dwordx4 v14, s[20:23], s49 offen offset:0 lds
    buffer_load_dwordx4 v15, s[20:23], s49 offen offset:1024 lds
    buffer_load_dwordx4 v16, s[20:23], s49 offen offset:2048 lds
    buffer_load_dwordx4 v17, s[20:23], s49 offen offset:3072 lds
    s_add_u32 s48, s48, 131072
    s_add_u32 s49, s49, 458752
    s_waitcnt vmcnt(8)
    s_barrier
    s_waitcnt vmcnt(0)
    s_barrier
    s_load_dwordx2 s[12:13], s[0:1], 0
    s_load_dwordx2 s[14:15], s[0:1], 88
    s_and_b32 s38, s32, 1
    s_lshr_b32 s39, s32, 1
    s_waitcnt lgkmcnt(0)

    s_mov_b32 s24, s10
    s_mov_b32 s25, s11
    s_and_b32 s25, s25, 0xffff
    s_mov_b32 s26, 0x1c00
    s_mov_b32 s27, 0x20000
    s_add_u32 s28, s4, 0xc00000
    s_addc_u32 s29, s5, 0
    s_and_b32 s29, s29, 0xffff
    s_mov_b32 s30, 0x700000
    s_mov_b32 s31, 0x20000
    s_lshl_b32 s43, s39, 6
    s_add_u32 s43, s43, s36
    v_add_u32 v4, s43, v3
    v_lshlrev_b32 v5, 1, v4

    buffer_load_ushort v12, v5, s[24:27], 0 offen offset:64
    buffer_load_ushort v13, v5, s[24:27], 0 offen offset:96
    s_lshr_b32 s44, s43, 6
    s_lshl_b32 s44, s44, 17
    s_lshl_b32 s45, s35, 7
    s_add_u32 s44, s44, s45
    s_lshl_b32 s45, s38, 7
    s_add_u32 s44, s44, s45
    v_lshlrev_b32 v6, 3, v2
    v_lshl_add_u32 v6, v3, 8, v6
    v_add_u32 v8, s44, v6

    s_mul_i32 s43, s32, 8192
    s_add_u32 s43, s43, 0
    v_lshlrev_b32 v15, 4, v0
    v_add_u32 v15, s43, v15
    s_barrier

    ds_read_b128 v[64:67], v15 offset:0
    ds_read_b128 v[68:71], v15 offset:1024
    ds_read_b128 v[72:75], v15 offset:2048
    ds_read_b128 v[76:79], v15 offset:3072
    ds_read_b128 v[80:83], v15 offset:4096
    ds_read_b128 v[84:87], v15 offset:5120
    ds_read_b128 v[88:91], v15 offset:6144
    ds_read_b128 v[92:95], v15 offset:7168
    s_waitcnt lgkmcnt(0)
    v_mov_b32 v1, 0xffff0000
    s_waitcnt vmcnt(0)

    v_mov_b32 v108, 0x3dd2d3e8
    v_mov_b32 v109, 0x3dd2d3e8
    v_mov_b32 v110, 0x40135761
    v_mov_b32 v111, 0x40135761
    v_mov_b32 v112, 1.0
    v_mov_b32 v113, 1.0

    v_lshlrev_b32 v114, 16, v12
    v_lshlrev_b32 v115, 16, v12
    v_add_u32 v7, 8192, v8
    v_cvt_pk_bf16_f32 v96, v64, v65
    v_cvt_pk_bf16_f32 v97, v66, v67
    v_lshlrev_b32 v64, 16, v96
    v_lshlrev_b32 v66, 16, v97
    v_and_b32 v65, v1, v96
    v_and_b32 v67, v1, v97
    v_pk_add_f32 v[64:65], v[64:65], v[114:115]
    v_pk_add_f32 v[66:67], v[66:67], v[114:115]
    v_cvt_pk_bf16_f32 v96, v64, v65
    v_cvt_pk_bf16_f32 v97, v66, v67
    v_lshlrev_b32 v64, 16, v96
    v_lshlrev_b32 v66, 16, v97
    v_and_b32 v65, v1, v96
    v_and_b32 v67, v1, v97
    v_pk_mul_f32 v[98:99], v[64:65], v[64:65]
    v_pk_mul_f32 v[100:101], v[66:67], v[66:67]
    v_pk_fma_f32 v[98:99], v[98:99], v[108:109], v[110:111]
    v_pk_fma_f32 v[100:101], v[100:101], v[108:109], v[110:111]
    v_pk_mul_f32 v[98:99], v[98:99], v[64:65]
    v_pk_mul_f32 v[100:101], v[100:101], v[66:67]
    v_exp_f32 v98, v98
    v_exp_f32 v100, v100
    v_exp_f32 v99, v99
    v_exp_f32 v101, v101
    v_pk_add_f32 v[98:99], v[98:99], v[112:113]
    v_pk_add_f32 v[100:101], v[100:101], v[112:113]
    v_rcp_f32 v98, v98
    v_rcp_f32 v100, v100
    v_rcp_f32 v99, v99
    v_rcp_f32 v101, v101
    v_pk_fma_f32 v[64:65], v[64:65], v[98:99], v[64:65] neg_lo:[1,0,0] neg_hi:[1,0,0]
    v_pk_fma_f32 v[66:67], v[66:67], v[100:101], v[66:67] neg_lo:[1,0,0] neg_hi:[1,0,0]
    v_cvt_pk_bf16_f32 v104, v64, v65
    v_cvt_pk_bf16_f32 v105, v66, v67
    buffer_store_dwordx2 v[104:105], v7, s[28:31], 0 offen offset:0
    v_cvt_pk_bf16_f32 v96, v68, v69
    v_cvt_pk_bf16_f32 v97, v70, v71
    v_lshlrev_b32 v68, 16, v96
    v_lshlrev_b32 v70, 16, v97
    v_and_b32 v69, v1, v96
    v_and_b32 v71, v1, v97
    v_pk_add_f32 v[68:69], v[68:69], v[114:115]
    v_pk_add_f32 v[70:71], v[70:71], v[114:115]
    v_cvt_pk_bf16_f32 v96, v68, v69
    v_cvt_pk_bf16_f32 v97, v70, v71
    v_lshlrev_b32 v68, 16, v96
    v_lshlrev_b32 v70, 16, v97
    v_and_b32 v69, v1, v96
    v_and_b32 v71, v1, v97
    v_pk_mul_f32 v[98:99], v[68:69], v[68:69]
    v_pk_mul_f32 v[100:101], v[70:71], v[70:71]
    v_pk_fma_f32 v[98:99], v[98:99], v[108:109], v[110:111]
    v_pk_fma_f32 v[100:101], v[100:101], v[108:109], v[110:111]
    v_pk_mul_f32 v[98:99], v[98:99], v[68:69]
    v_pk_mul_f32 v[100:101], v[100:101], v[70:71]
    v_exp_f32 v98, v98
    v_exp_f32 v100, v100
    v_exp_f32 v99, v99
    v_exp_f32 v101, v101
    v_pk_add_f32 v[98:99], v[98:99], v[112:113]
    v_pk_add_f32 v[100:101], v[100:101], v[112:113]
    v_rcp_f32 v98, v98
    v_rcp_f32 v100, v100
    v_rcp_f32 v99, v99
    v_rcp_f32 v101, v101
    v_pk_fma_f32 v[68:69], v[68:69], v[98:99], v[68:69] neg_lo:[1,0,0] neg_hi:[1,0,0]
    v_pk_fma_f32 v[70:71], v[70:71], v[100:101], v[70:71] neg_lo:[1,0,0] neg_hi:[1,0,0]
    v_cvt_pk_bf16_f32 v106, v68, v69
    v_cvt_pk_bf16_f32 v107, v70, v71
    buffer_store_dwordx2 v[106:107], v7, s[28:31], 0 offen offset:32
    v_cvt_pk_bf16_f32 v96, v72, v73
    v_cvt_pk_bf16_f32 v97, v74, v75
    v_lshlrev_b32 v72, 16, v96
    v_lshlrev_b32 v74, 16, v97
    v_and_b32 v73, v1, v96
    v_and_b32 v75, v1, v97
    v_pk_add_f32 v[72:73], v[72:73], v[114:115]
    v_pk_add_f32 v[74:75], v[74:75], v[114:115]
    v_cvt_pk_bf16_f32 v96, v72, v73
    v_cvt_pk_bf16_f32 v97, v74, v75
    v_lshlrev_b32 v72, 16, v96
    v_lshlrev_b32 v74, 16, v97
    v_and_b32 v73, v1, v96
    v_and_b32 v75, v1, v97
    v_pk_mul_f32 v[98:99], v[72:73], v[72:73]
    v_pk_mul_f32 v[100:101], v[74:75], v[74:75]
    v_pk_fma_f32 v[98:99], v[98:99], v[108:109], v[110:111]
    v_pk_fma_f32 v[100:101], v[100:101], v[108:109], v[110:111]
    v_pk_mul_f32 v[98:99], v[98:99], v[72:73]
    v_pk_mul_f32 v[100:101], v[100:101], v[74:75]
    v_exp_f32 v98, v98
    v_exp_f32 v100, v100
    v_exp_f32 v99, v99
    v_exp_f32 v101, v101
    v_pk_add_f32 v[98:99], v[98:99], v[112:113]
    v_pk_add_f32 v[100:101], v[100:101], v[112:113]
    v_rcp_f32 v98, v98
    v_rcp_f32 v100, v100
    v_rcp_f32 v99, v99
    v_rcp_f32 v101, v101
    v_pk_fma_f32 v[72:73], v[72:73], v[98:99], v[72:73] neg_lo:[1,0,0] neg_hi:[1,0,0]
    v_pk_fma_f32 v[74:75], v[74:75], v[100:101], v[74:75] neg_lo:[1,0,0] neg_hi:[1,0,0]
    v_cvt_pk_bf16_f32 v104, v72, v73
    v_cvt_pk_bf16_f32 v105, v74, v75
    buffer_store_dwordx2 v[104:105], v7, s[28:31], 0 offen offset:64
    v_cvt_pk_bf16_f32 v96, v76, v77
    v_cvt_pk_bf16_f32 v97, v78, v79
    v_lshlrev_b32 v76, 16, v96
    v_lshlrev_b32 v78, 16, v97
    v_and_b32 v77, v1, v96
    v_and_b32 v79, v1, v97
    v_pk_add_f32 v[76:77], v[76:77], v[114:115]
    v_pk_add_f32 v[78:79], v[78:79], v[114:115]
    v_cvt_pk_bf16_f32 v96, v76, v77
    v_cvt_pk_bf16_f32 v97, v78, v79
    v_lshlrev_b32 v76, 16, v96
    v_lshlrev_b32 v78, 16, v97
    v_and_b32 v77, v1, v96
    v_and_b32 v79, v1, v97
    v_pk_mul_f32 v[98:99], v[76:77], v[76:77]
    v_pk_mul_f32 v[100:101], v[78:79], v[78:79]
    v_pk_fma_f32 v[98:99], v[98:99], v[108:109], v[110:111]
    v_pk_fma_f32 v[100:101], v[100:101], v[108:109], v[110:111]
    v_pk_mul_f32 v[98:99], v[98:99], v[76:77]
    v_pk_mul_f32 v[100:101], v[100:101], v[78:79]
    v_exp_f32 v98, v98
    v_exp_f32 v100, v100
    v_exp_f32 v99, v99
    v_exp_f32 v101, v101
    v_pk_add_f32 v[98:99], v[98:99], v[112:113]
    v_pk_add_f32 v[100:101], v[100:101], v[112:113]
    v_rcp_f32 v98, v98
    v_rcp_f32 v100, v100
    v_rcp_f32 v99, v99
    v_rcp_f32 v101, v101
    v_pk_fma_f32 v[76:77], v[76:77], v[98:99], v[76:77] neg_lo:[1,0,0] neg_hi:[1,0,0]
    v_pk_fma_f32 v[78:79], v[78:79], v[100:101], v[78:79] neg_lo:[1,0,0] neg_hi:[1,0,0]
    v_cvt_pk_bf16_f32 v106, v76, v77
    v_cvt_pk_bf16_f32 v107, v78, v79
    buffer_store_dwordx2 v[106:107], v7, s[28:31], 0 offen offset:96
    v_lshlrev_b32 v114, 16, v13
    v_lshlrev_b32 v115, 16, v13
    v_add_u32 v7, 12288, v8
    v_cvt_pk_bf16_f32 v96, v80, v81
    v_cvt_pk_bf16_f32 v97, v82, v83
    v_lshlrev_b32 v80, 16, v96
    v_lshlrev_b32 v82, 16, v97
    v_and_b32 v81, v1, v96
    v_and_b32 v83, v1, v97
    v_pk_add_f32 v[80:81], v[80:81], v[114:115]
    v_pk_add_f32 v[82:83], v[82:83], v[114:115]
    v_cvt_pk_bf16_f32 v96, v80, v81
    v_cvt_pk_bf16_f32 v97, v82, v83
    v_lshlrev_b32 v80, 16, v96
    v_lshlrev_b32 v82, 16, v97
    v_and_b32 v81, v1, v96
    v_and_b32 v83, v1, v97
    v_pk_mul_f32 v[98:99], v[80:81], v[80:81]
    v_pk_mul_f32 v[100:101], v[82:83], v[82:83]
    v_pk_fma_f32 v[98:99], v[98:99], v[108:109], v[110:111]
    v_pk_fma_f32 v[100:101], v[100:101], v[108:109], v[110:111]
    v_pk_mul_f32 v[98:99], v[98:99], v[80:81]
    v_pk_mul_f32 v[100:101], v[100:101], v[82:83]
    v_exp_f32 v98, v98
    v_exp_f32 v100, v100
    v_exp_f32 v99, v99
    v_exp_f32 v101, v101
    v_pk_add_f32 v[98:99], v[98:99], v[112:113]
    v_pk_add_f32 v[100:101], v[100:101], v[112:113]
    v_rcp_f32 v98, v98
    v_rcp_f32 v100, v100
    v_rcp_f32 v99, v99
    v_rcp_f32 v101, v101
    v_pk_fma_f32 v[80:81], v[80:81], v[98:99], v[80:81] neg_lo:[1,0,0] neg_hi:[1,0,0]
    v_pk_fma_f32 v[82:83], v[82:83], v[100:101], v[82:83] neg_lo:[1,0,0] neg_hi:[1,0,0]
    v_cvt_pk_bf16_f32 v104, v80, v81
    v_cvt_pk_bf16_f32 v105, v82, v83
    buffer_store_dwordx2 v[104:105], v7, s[28:31], 0 offen offset:0
    v_cvt_pk_bf16_f32 v96, v84, v85
    v_cvt_pk_bf16_f32 v97, v86, v87
    v_lshlrev_b32 v84, 16, v96
    v_lshlrev_b32 v86, 16, v97
    v_and_b32 v85, v1, v96
    v_and_b32 v87, v1, v97
    v_pk_add_f32 v[84:85], v[84:85], v[114:115]
    v_pk_add_f32 v[86:87], v[86:87], v[114:115]
    v_cvt_pk_bf16_f32 v96, v84, v85
    v_cvt_pk_bf16_f32 v97, v86, v87
    v_lshlrev_b32 v84, 16, v96
    v_lshlrev_b32 v86, 16, v97
    v_and_b32 v85, v1, v96
    v_and_b32 v87, v1, v97
    v_pk_mul_f32 v[98:99], v[84:85], v[84:85]
    v_pk_mul_f32 v[100:101], v[86:87], v[86:87]
    v_pk_fma_f32 v[98:99], v[98:99], v[108:109], v[110:111]
    v_pk_fma_f32 v[100:101], v[100:101], v[108:109], v[110:111]
    v_pk_mul_f32 v[98:99], v[98:99], v[84:85]
    v_pk_mul_f32 v[100:101], v[100:101], v[86:87]
    v_exp_f32 v98, v98
    v_exp_f32 v100, v100
    v_exp_f32 v99, v99
    v_exp_f32 v101, v101
    v_pk_add_f32 v[98:99], v[98:99], v[112:113]
    v_pk_add_f32 v[100:101], v[100:101], v[112:113]
    v_rcp_f32 v98, v98
    v_rcp_f32 v100, v100
    v_rcp_f32 v99, v99
    v_rcp_f32 v101, v101
    v_pk_fma_f32 v[84:85], v[84:85], v[98:99], v[84:85] neg_lo:[1,0,0] neg_hi:[1,0,0]
    v_pk_fma_f32 v[86:87], v[86:87], v[100:101], v[86:87] neg_lo:[1,0,0] neg_hi:[1,0,0]
    v_cvt_pk_bf16_f32 v106, v84, v85
    v_cvt_pk_bf16_f32 v107, v86, v87
    buffer_store_dwordx2 v[106:107], v7, s[28:31], 0 offen offset:32
    v_cvt_pk_bf16_f32 v96, v88, v89
    v_cvt_pk_bf16_f32 v97, v90, v91
    v_lshlrev_b32 v88, 16, v96
    v_lshlrev_b32 v90, 16, v97
    v_and_b32 v89, v1, v96
    v_and_b32 v91, v1, v97
    v_pk_add_f32 v[88:89], v[88:89], v[114:115]
    v_pk_add_f32 v[90:91], v[90:91], v[114:115]
    v_cvt_pk_bf16_f32 v96, v88, v89
    v_cvt_pk_bf16_f32 v97, v90, v91
    v_lshlrev_b32 v88, 16, v96
    v_lshlrev_b32 v90, 16, v97
    v_and_b32 v89, v1, v96
    v_and_b32 v91, v1, v97
    v_pk_mul_f32 v[98:99], v[88:89], v[88:89]
    v_pk_mul_f32 v[100:101], v[90:91], v[90:91]
    v_pk_fma_f32 v[98:99], v[98:99], v[108:109], v[110:111]
    v_pk_fma_f32 v[100:101], v[100:101], v[108:109], v[110:111]
    v_pk_mul_f32 v[98:99], v[98:99], v[88:89]
    v_pk_mul_f32 v[100:101], v[100:101], v[90:91]
    v_exp_f32 v98, v98
    v_exp_f32 v100, v100
    v_exp_f32 v99, v99
    v_exp_f32 v101, v101
    v_pk_add_f32 v[98:99], v[98:99], v[112:113]
    v_pk_add_f32 v[100:101], v[100:101], v[112:113]
    v_rcp_f32 v98, v98
    v_rcp_f32 v100, v100
    v_rcp_f32 v99, v99
    v_rcp_f32 v101, v101
    v_pk_fma_f32 v[88:89], v[88:89], v[98:99], v[88:89] neg_lo:[1,0,0] neg_hi:[1,0,0]
    v_pk_fma_f32 v[90:91], v[90:91], v[100:101], v[90:91] neg_lo:[1,0,0] neg_hi:[1,0,0]
    v_cvt_pk_bf16_f32 v104, v88, v89
    v_cvt_pk_bf16_f32 v105, v90, v91
    buffer_store_dwordx2 v[104:105], v7, s[28:31], 0 offen offset:64
    v_cvt_pk_bf16_f32 v96, v92, v93
    v_cvt_pk_bf16_f32 v97, v94, v95
    v_lshlrev_b32 v92, 16, v96
    v_lshlrev_b32 v94, 16, v97
    v_and_b32 v93, v1, v96
    v_and_b32 v95, v1, v97
    v_pk_add_f32 v[92:93], v[92:93], v[114:115]
    v_pk_add_f32 v[94:95], v[94:95], v[114:115]
    v_cvt_pk_bf16_f32 v96, v92, v93
    v_cvt_pk_bf16_f32 v97, v94, v95
    v_lshlrev_b32 v92, 16, v96
    v_lshlrev_b32 v94, 16, v97
    v_and_b32 v93, v1, v96
    v_and_b32 v95, v1, v97
    v_pk_mul_f32 v[98:99], v[92:93], v[92:93]
    v_pk_mul_f32 v[100:101], v[94:95], v[94:95]
    v_pk_fma_f32 v[98:99], v[98:99], v[108:109], v[110:111]
    v_pk_fma_f32 v[100:101], v[100:101], v[108:109], v[110:111]
    v_pk_mul_f32 v[98:99], v[98:99], v[92:93]
    v_pk_mul_f32 v[100:101], v[100:101], v[94:95]
    v_exp_f32 v98, v98
    v_exp_f32 v100, v100
    v_exp_f32 v99, v99
    v_exp_f32 v101, v101
    v_pk_add_f32 v[98:99], v[98:99], v[112:113]
    v_pk_add_f32 v[100:101], v[100:101], v[112:113]
    v_rcp_f32 v98, v98
    v_rcp_f32 v100, v100
    v_rcp_f32 v99, v99
    v_rcp_f32 v101, v101
    v_pk_fma_f32 v[92:93], v[92:93], v[98:99], v[92:93] neg_lo:[1,0,0] neg_hi:[1,0,0]
    v_pk_fma_f32 v[94:95], v[94:95], v[100:101], v[94:95] neg_lo:[1,0,0] neg_hi:[1,0,0]
    v_cvt_pk_bf16_f32 v106, v92, v93
    v_cvt_pk_bf16_f32 v107, v94, v95
    buffer_store_dwordx2 v[106:107], v7, s[28:31], 0 offen offset:96
    s_endpgm
gemm1_kernel_compute:
    s_and_b32 s38, s32, 1
    s_lshr_b32 s39, s32, 1
    s_lshl_b32 s43, s38, 2

    v_bfe_u32 v4, v0, 2, 2
    v_lshl_add_u32 v4, v2, 2, v4
    v_and_b32 v5, 3, v0
    v_lshlrev_b32 v5, 3, v5
    v_lshl_add_u32 v6, v4, 8, v5
    v_and_b32 v7, 7, v4

    s_add_u32 s44, s43, 0
    v_xor_b32 v8, s44, v7
    v_lshl_add_u32 v16, v8, 5, v6
    v_add_u32 v20, 65536, v16

    s_add_u32 s44, s43, 1
    v_xor_b32 v8, s44, v7
    v_lshl_add_u32 v17, v8, 5, v6
    v_add_u32 v21, 65536, v17

    s_add_u32 s44, s43, 2
    v_xor_b32 v8, s44, v7
    v_lshl_add_u32 v18, v8, 5, v6
    v_add_u32 v22, 65536, v18

    s_add_u32 s44, s43, 3
    v_xor_b32 v8, s44, v7
    v_lshl_add_u32 v19, v8, 5, v6
    v_add_u32 v23, 65536, v19

    s_lshl_b32 s43, s39, 2
    s_add_u32 s44, s43, 0
    v_xor_b32 v8, s44, v7
    v_lshl_add_u32 v24, v8, 5, v6
    v_add_u32 v28, 65536, v24

    s_add_u32 s44, s43, 1
    v_xor_b32 v8, s44, v7
    v_lshl_add_u32 v25, v8, 5, v6
    v_add_u32 v29, 65536, v25

    s_add_u32 s44, s43, 2
    v_xor_b32 v8, s44, v7
    v_lshl_add_u32 v26, v8, 5, v6
    v_add_u32 v30, 65536, v26

    s_add_u32 s44, s43, 3
    v_xor_b32 v8, s44, v7
    v_lshl_add_u32 v27, v8, 5, v6
    v_add_u32 v31, 65536, v27

    v_mov_b32 v32, 0
    v_mov_b32 v33, 0
    v_mov_b32 v34, 0
    v_mov_b32 v35, 0
    v_mov_b32 v36, 0
    v_mov_b32 v37, 0
    v_mov_b32 v38, 0
    v_mov_b32 v39, 0
    v_mov_b32 v40, 0
    v_mov_b32 v41, 0
    v_mov_b32 v42, 0
    v_mov_b32 v43, 0
    v_mov_b32 v44, 0
    v_mov_b32 v45, 0
    v_mov_b32 v46, 0
    v_mov_b32 v47, 0
    v_mov_b32 v48, 0
    v_mov_b32 v49, 0
    v_mov_b32 v50, 0
    v_mov_b32 v51, 0
    v_mov_b32 v52, 0
    v_mov_b32 v53, 0
    v_mov_b32 v54, 0
    v_mov_b32 v55, 0
    v_mov_b32 v56, 0
    v_mov_b32 v57, 0
    v_mov_b32 v58, 0
    v_mov_b32 v59, 0
    v_mov_b32 v60, 0
    v_mov_b32 v61, 0
    v_mov_b32 v62, 0
    v_mov_b32 v63, 0
    v_mov_b32 v64, 0
    v_mov_b32 v65, 0
    v_mov_b32 v66, 0
    v_mov_b32 v67, 0
    v_mov_b32 v68, 0
    v_mov_b32 v69, 0
    v_mov_b32 v70, 0
    v_mov_b32 v71, 0
    v_mov_b32 v72, 0
    v_mov_b32 v73, 0
    v_mov_b32 v74, 0
    v_mov_b32 v75, 0
    v_mov_b32 v76, 0
    v_mov_b32 v77, 0
    v_mov_b32 v78, 0
    v_mov_b32 v79, 0
    v_mov_b32 v80, 0
    v_mov_b32 v81, 0
    v_mov_b32 v82, 0
    v_mov_b32 v83, 0
    v_mov_b32 v84, 0
    v_mov_b32 v85, 0
    v_mov_b32 v86, 0
    v_mov_b32 v87, 0
    v_mov_b32 v88, 0
    v_mov_b32 v89, 0
    v_mov_b32 v90, 0
    v_mov_b32 v91, 0
    v_mov_b32 v92, 0
    v_mov_b32 v93, 0
    v_mov_b32 v94, 0
    v_mov_b32 v95, 0
    s_load_dwordx2 s[12:13], s[0:1], 0
    s_load_dwordx2 s[14:15], s[0:1], 88
    s_waitcnt lgkmcnt(0)

    s_barrier
    ds_read_b64_tr_b16 v[96:97], v16 offset:0
    ds_read_b64_tr_b16 v[98:99], v16 offset:4096
    ds_read_b64_tr_b16 v[100:101], v17 offset:0
    ds_read_b64_tr_b16 v[102:103], v17 offset:4096
    ds_read_b64_tr_b16 v[104:105], v18 offset:0
    ds_read_b64_tr_b16 v[106:107], v18 offset:4096
    ds_read_b64_tr_b16 v[108:109], v19 offset:0
    ds_read_b64_tr_b16 v[110:111], v19 offset:4096
    ds_read_b64_tr_b16 v[112:113], v24 offset:16384
    ds_read_b64_tr_b16 v[114:115], v24 offset:20480
    ds_read_b64_tr_b16 v[116:117], v25 offset:16384
    ds_read_b64_tr_b16 v[118:119], v25 offset:20480
    ds_read_b64_tr_b16 v[120:121], v26 offset:16384
    ds_read_b64_tr_b16 v[122:123], v26 offset:20480
    ds_read_b64_tr_b16 v[124:125], v27 offset:16384
    ds_read_b64_tr_b16 v[126:127], v27 offset:20480
    s_mov_b32 s50, 9
gemm1_kernel_loop:
    s_waitcnt lgkmcnt(0)
    v_mfma_f32_16x16x32_bf16 v[32:35], v[96:99], v[112:115], v[32:35]
    ds_read_b64_tr_b16 v[128:129], v16 offset:8192
    ds_read_b64_tr_b16 v[130:131], v16 offset:12288
    v_mfma_f32_16x16x32_bf16 v[36:39], v[100:103], v[112:115], v[36:39]
    ds_read_b64_tr_b16 v[132:133], v17 offset:8192
    ds_read_b64_tr_b16 v[134:135], v17 offset:12288
    v_mfma_f32_16x16x32_bf16 v[40:43], v[104:107], v[112:115], v[40:43]
    ds_read_b64_tr_b16 v[136:137], v18 offset:8192
    ds_read_b64_tr_b16 v[138:139], v18 offset:12288
    v_mfma_f32_16x16x32_bf16 v[44:47], v[108:111], v[112:115], v[44:47]
    ds_read_b64_tr_b16 v[140:141], v19 offset:8192
    ds_read_b64_tr_b16 v[142:143], v19 offset:12288
    v_mfma_f32_16x16x32_bf16 v[48:51], v[96:99], v[116:119], v[48:51]
    ds_read_b64_tr_b16 v[144:145], v24 offset:24576
    ds_read_b64_tr_b16 v[146:147], v24 offset:28672
    v_mfma_f32_16x16x32_bf16 v[52:55], v[100:103], v[116:119], v[52:55]
    ds_read_b64_tr_b16 v[148:149], v25 offset:24576
    ds_read_b64_tr_b16 v[150:151], v25 offset:28672
    v_mfma_f32_16x16x32_bf16 v[56:59], v[104:107], v[116:119], v[56:59]
    ds_read_b64_tr_b16 v[152:153], v26 offset:24576
    ds_read_b64_tr_b16 v[154:155], v26 offset:28672
    v_mfma_f32_16x16x32_bf16 v[60:63], v[108:111], v[116:119], v[60:63]
    ds_read_b64_tr_b16 v[156:157], v27 offset:24576
    ds_read_b64_tr_b16 v[158:159], v27 offset:28672
    v_mfma_f32_16x16x32_bf16 v[64:67], v[96:99], v[120:123], v[64:67]
    v_mfma_f32_16x16x32_bf16 v[68:71], v[100:103], v[120:123], v[68:71]
    v_mfma_f32_16x16x32_bf16 v[72:75], v[104:107], v[120:123], v[72:75]
    v_mfma_f32_16x16x32_bf16 v[76:79], v[108:111], v[120:123], v[76:79]
    v_mfma_f32_16x16x32_bf16 v[80:83], v[96:99], v[124:127], v[80:83]
    v_mfma_f32_16x16x32_bf16 v[84:87], v[100:103], v[124:127], v[84:87]
    v_mfma_f32_16x16x32_bf16 v[88:91], v[104:107], v[124:127], v[88:91]
    v_mfma_f32_16x16x32_bf16 v[92:95], v[108:111], v[124:127], v[92:95]
    s_waitcnt lgkmcnt(0)
    s_barrier
    v_mfma_f32_16x16x32_bf16 v[32:35], v[128:131], v[144:147], v[32:35]
    ds_read_b64_tr_b16 v[96:97], v16 offset:32768
    ds_read_b64_tr_b16 v[98:99], v16 offset:36864
    v_mfma_f32_16x16x32_bf16 v[36:39], v[132:135], v[144:147], v[36:39]
    ds_read_b64_tr_b16 v[100:101], v17 offset:32768
    ds_read_b64_tr_b16 v[102:103], v17 offset:36864
    v_mfma_f32_16x16x32_bf16 v[40:43], v[136:139], v[144:147], v[40:43]
    ds_read_b64_tr_b16 v[104:105], v18 offset:32768
    ds_read_b64_tr_b16 v[106:107], v18 offset:36864
    v_mfma_f32_16x16x32_bf16 v[44:47], v[140:143], v[144:147], v[44:47]
    ds_read_b64_tr_b16 v[108:109], v19 offset:32768
    ds_read_b64_tr_b16 v[110:111], v19 offset:36864
    v_mfma_f32_16x16x32_bf16 v[48:51], v[128:131], v[148:151], v[48:51]
    ds_read_b64_tr_b16 v[112:113], v24 offset:49152
    ds_read_b64_tr_b16 v[114:115], v24 offset:53248
    v_mfma_f32_16x16x32_bf16 v[52:55], v[132:135], v[148:151], v[52:55]
    ds_read_b64_tr_b16 v[116:117], v25 offset:49152
    ds_read_b64_tr_b16 v[118:119], v25 offset:53248
    v_mfma_f32_16x16x32_bf16 v[56:59], v[136:139], v[148:151], v[56:59]
    ds_read_b64_tr_b16 v[120:121], v26 offset:49152
    ds_read_b64_tr_b16 v[122:123], v26 offset:53248
    v_mfma_f32_16x16x32_bf16 v[60:63], v[140:143], v[148:151], v[60:63]
    ds_read_b64_tr_b16 v[124:125], v27 offset:49152
    ds_read_b64_tr_b16 v[126:127], v27 offset:53248
    v_mfma_f32_16x16x32_bf16 v[64:67], v[128:131], v[152:155], v[64:67]
    v_mfma_f32_16x16x32_bf16 v[68:71], v[132:135], v[152:155], v[68:71]
    v_mfma_f32_16x16x32_bf16 v[72:75], v[136:139], v[152:155], v[72:75]
    v_mfma_f32_16x16x32_bf16 v[76:79], v[140:143], v[152:155], v[76:79]
    v_mfma_f32_16x16x32_bf16 v[80:83], v[128:131], v[156:159], v[80:83]
    v_mfma_f32_16x16x32_bf16 v[84:87], v[132:135], v[156:159], v[84:87]
    v_mfma_f32_16x16x32_bf16 v[88:91], v[136:139], v[156:159], v[88:91]
    v_mfma_f32_16x16x32_bf16 v[92:95], v[140:143], v[156:159], v[92:95]
    s_waitcnt lgkmcnt(0)
    v_mfma_f32_16x16x32_bf16 v[32:35], v[96:99], v[112:115], v[32:35]
    ds_read_b64_tr_b16 v[128:129], v16 offset:40960
    ds_read_b64_tr_b16 v[130:131], v16 offset:45056
    v_mfma_f32_16x16x32_bf16 v[36:39], v[100:103], v[112:115], v[36:39]
    ds_read_b64_tr_b16 v[132:133], v17 offset:40960
    ds_read_b64_tr_b16 v[134:135], v17 offset:45056
    v_mfma_f32_16x16x32_bf16 v[40:43], v[104:107], v[112:115], v[40:43]
    ds_read_b64_tr_b16 v[136:137], v18 offset:40960
    ds_read_b64_tr_b16 v[138:139], v18 offset:45056
    v_mfma_f32_16x16x32_bf16 v[44:47], v[108:111], v[112:115], v[44:47]
    ds_read_b64_tr_b16 v[140:141], v19 offset:40960
    ds_read_b64_tr_b16 v[142:143], v19 offset:45056
    v_mfma_f32_16x16x32_bf16 v[48:51], v[96:99], v[116:119], v[48:51]
    ds_read_b64_tr_b16 v[144:145], v24 offset:57344
    ds_read_b64_tr_b16 v[146:147], v24 offset:61440
    v_mfma_f32_16x16x32_bf16 v[52:55], v[100:103], v[116:119], v[52:55]
    ds_read_b64_tr_b16 v[148:149], v25 offset:57344
    ds_read_b64_tr_b16 v[150:151], v25 offset:61440
    v_mfma_f32_16x16x32_bf16 v[56:59], v[104:107], v[116:119], v[56:59]
    ds_read_b64_tr_b16 v[152:153], v26 offset:57344
    ds_read_b64_tr_b16 v[154:155], v26 offset:61440
    v_mfma_f32_16x16x32_bf16 v[60:63], v[108:111], v[116:119], v[60:63]
    ds_read_b64_tr_b16 v[156:157], v27 offset:57344
    ds_read_b64_tr_b16 v[158:159], v27 offset:61440
    v_mfma_f32_16x16x32_bf16 v[64:67], v[96:99], v[120:123], v[64:67]
    v_mfma_f32_16x16x32_bf16 v[68:71], v[100:103], v[120:123], v[68:71]
    v_mfma_f32_16x16x32_bf16 v[72:75], v[104:107], v[120:123], v[72:75]
    v_mfma_f32_16x16x32_bf16 v[76:79], v[108:111], v[120:123], v[76:79]
    v_mfma_f32_16x16x32_bf16 v[80:83], v[96:99], v[124:127], v[80:83]
    v_mfma_f32_16x16x32_bf16 v[84:87], v[100:103], v[124:127], v[84:87]
    v_mfma_f32_16x16x32_bf16 v[88:91], v[104:107], v[124:127], v[88:91]
    v_mfma_f32_16x16x32_bf16 v[92:95], v[108:111], v[124:127], v[92:95]
    s_waitcnt lgkmcnt(0)
    s_barrier
    v_mfma_f32_16x16x32_bf16 v[32:35], v[128:131], v[144:147], v[32:35]
    ds_read_b64_tr_b16 v[96:97], v20 offset:0
    ds_read_b64_tr_b16 v[98:99], v20 offset:4096
    v_mfma_f32_16x16x32_bf16 v[36:39], v[132:135], v[144:147], v[36:39]
    ds_read_b64_tr_b16 v[100:101], v21 offset:0
    ds_read_b64_tr_b16 v[102:103], v21 offset:4096
    v_mfma_f32_16x16x32_bf16 v[40:43], v[136:139], v[144:147], v[40:43]
    ds_read_b64_tr_b16 v[104:105], v22 offset:0
    ds_read_b64_tr_b16 v[106:107], v22 offset:4096
    v_mfma_f32_16x16x32_bf16 v[44:47], v[140:143], v[144:147], v[44:47]
    ds_read_b64_tr_b16 v[108:109], v23 offset:0
    ds_read_b64_tr_b16 v[110:111], v23 offset:4096
    v_mfma_f32_16x16x32_bf16 v[48:51], v[128:131], v[148:151], v[48:51]
    ds_read_b64_tr_b16 v[112:113], v28 offset:16384
    ds_read_b64_tr_b16 v[114:115], v28 offset:20480
    v_mfma_f32_16x16x32_bf16 v[52:55], v[132:135], v[148:151], v[52:55]
    ds_read_b64_tr_b16 v[116:117], v29 offset:16384
    ds_read_b64_tr_b16 v[118:119], v29 offset:20480
    v_mfma_f32_16x16x32_bf16 v[56:59], v[136:139], v[148:151], v[56:59]
    ds_read_b64_tr_b16 v[120:121], v30 offset:16384
    ds_read_b64_tr_b16 v[122:123], v30 offset:20480
    v_mfma_f32_16x16x32_bf16 v[60:63], v[140:143], v[148:151], v[60:63]
    ds_read_b64_tr_b16 v[124:125], v31 offset:16384
    ds_read_b64_tr_b16 v[126:127], v31 offset:20480
    v_mfma_f32_16x16x32_bf16 v[64:67], v[128:131], v[152:155], v[64:67]
    v_mfma_f32_16x16x32_bf16 v[68:71], v[132:135], v[152:155], v[68:71]
    v_mfma_f32_16x16x32_bf16 v[72:75], v[136:139], v[152:155], v[72:75]
    v_mfma_f32_16x16x32_bf16 v[76:79], v[140:143], v[152:155], v[76:79]
    v_mfma_f32_16x16x32_bf16 v[80:83], v[128:131], v[156:159], v[80:83]
    v_mfma_f32_16x16x32_bf16 v[84:87], v[132:135], v[156:159], v[84:87]
    v_mfma_f32_16x16x32_bf16 v[88:91], v[136:139], v[156:159], v[88:91]
    v_mfma_f32_16x16x32_bf16 v[92:95], v[140:143], v[156:159], v[92:95]
    s_waitcnt lgkmcnt(0)
    v_mfma_f32_16x16x32_bf16 v[32:35], v[96:99], v[112:115], v[32:35]
    ds_read_b64_tr_b16 v[128:129], v20 offset:8192
    ds_read_b64_tr_b16 v[130:131], v20 offset:12288
    v_mfma_f32_16x16x32_bf16 v[36:39], v[100:103], v[112:115], v[36:39]
    ds_read_b64_tr_b16 v[132:133], v21 offset:8192
    ds_read_b64_tr_b16 v[134:135], v21 offset:12288
    v_mfma_f32_16x16x32_bf16 v[40:43], v[104:107], v[112:115], v[40:43]
    ds_read_b64_tr_b16 v[136:137], v22 offset:8192
    ds_read_b64_tr_b16 v[138:139], v22 offset:12288
    v_mfma_f32_16x16x32_bf16 v[44:47], v[108:111], v[112:115], v[44:47]
    ds_read_b64_tr_b16 v[140:141], v23 offset:8192
    ds_read_b64_tr_b16 v[142:143], v23 offset:12288
    v_mfma_f32_16x16x32_bf16 v[48:51], v[96:99], v[116:119], v[48:51]
    ds_read_b64_tr_b16 v[144:145], v28 offset:24576
    ds_read_b64_tr_b16 v[146:147], v28 offset:28672
    v_mfma_f32_16x16x32_bf16 v[52:55], v[100:103], v[116:119], v[52:55]
    ds_read_b64_tr_b16 v[148:149], v29 offset:24576
    ds_read_b64_tr_b16 v[150:151], v29 offset:28672
    v_mfma_f32_16x16x32_bf16 v[56:59], v[104:107], v[116:119], v[56:59]
    ds_read_b64_tr_b16 v[152:153], v30 offset:24576
    ds_read_b64_tr_b16 v[154:155], v30 offset:28672
    v_mfma_f32_16x16x32_bf16 v[60:63], v[108:111], v[116:119], v[60:63]
    ds_read_b64_tr_b16 v[156:157], v31 offset:24576
    ds_read_b64_tr_b16 v[158:159], v31 offset:28672
    v_mfma_f32_16x16x32_bf16 v[64:67], v[96:99], v[120:123], v[64:67]
    v_mfma_f32_16x16x32_bf16 v[68:71], v[100:103], v[120:123], v[68:71]
    v_mfma_f32_16x16x32_bf16 v[72:75], v[104:107], v[120:123], v[72:75]
    v_mfma_f32_16x16x32_bf16 v[76:79], v[108:111], v[120:123], v[76:79]
    v_mfma_f32_16x16x32_bf16 v[80:83], v[96:99], v[124:127], v[80:83]
    v_mfma_f32_16x16x32_bf16 v[84:87], v[100:103], v[124:127], v[84:87]
    v_mfma_f32_16x16x32_bf16 v[88:91], v[104:107], v[124:127], v[88:91]
    v_mfma_f32_16x16x32_bf16 v[92:95], v[108:111], v[124:127], v[92:95]
    s_waitcnt lgkmcnt(0)
    s_barrier
    v_mfma_f32_16x16x32_bf16 v[32:35], v[128:131], v[144:147], v[32:35]
    ds_read_b64_tr_b16 v[96:97], v16 offset:0
    ds_read_b64_tr_b16 v[98:99], v16 offset:4096
    v_mfma_f32_16x16x32_bf16 v[36:39], v[132:135], v[144:147], v[36:39]
    ds_read_b64_tr_b16 v[100:101], v17 offset:0
    ds_read_b64_tr_b16 v[102:103], v17 offset:4096
    v_mfma_f32_16x16x32_bf16 v[40:43], v[136:139], v[144:147], v[40:43]
    ds_read_b64_tr_b16 v[104:105], v18 offset:0
    ds_read_b64_tr_b16 v[106:107], v18 offset:4096
    v_mfma_f32_16x16x32_bf16 v[44:47], v[140:143], v[144:147], v[44:47]
    ds_read_b64_tr_b16 v[108:109], v19 offset:0
    ds_read_b64_tr_b16 v[110:111], v19 offset:4096
    v_mfma_f32_16x16x32_bf16 v[48:51], v[128:131], v[148:151], v[48:51]
    ds_read_b64_tr_b16 v[112:113], v24 offset:16384
    ds_read_b64_tr_b16 v[114:115], v24 offset:20480
    v_mfma_f32_16x16x32_bf16 v[52:55], v[132:135], v[148:151], v[52:55]
    ds_read_b64_tr_b16 v[116:117], v25 offset:16384
    ds_read_b64_tr_b16 v[118:119], v25 offset:20480
    v_mfma_f32_16x16x32_bf16 v[56:59], v[136:139], v[148:151], v[56:59]
    ds_read_b64_tr_b16 v[120:121], v26 offset:16384
    ds_read_b64_tr_b16 v[122:123], v26 offset:20480
    v_mfma_f32_16x16x32_bf16 v[60:63], v[140:143], v[148:151], v[60:63]
    ds_read_b64_tr_b16 v[124:125], v27 offset:16384
    ds_read_b64_tr_b16 v[126:127], v27 offset:20480
    v_mfma_f32_16x16x32_bf16 v[64:67], v[128:131], v[152:155], v[64:67]
    v_mfma_f32_16x16x32_bf16 v[68:71], v[132:135], v[152:155], v[68:71]
    v_mfma_f32_16x16x32_bf16 v[72:75], v[136:139], v[152:155], v[72:75]
    v_mfma_f32_16x16x32_bf16 v[76:79], v[140:143], v[152:155], v[76:79]
    v_mfma_f32_16x16x32_bf16 v[80:83], v[128:131], v[156:159], v[80:83]
    v_mfma_f32_16x16x32_bf16 v[84:87], v[132:135], v[156:159], v[84:87]
    v_mfma_f32_16x16x32_bf16 v[88:91], v[136:139], v[156:159], v[88:91]
    v_mfma_f32_16x16x32_bf16 v[92:95], v[140:143], v[156:159], v[92:95]
    s_sub_u32 s50, s50, 1
    s_cmp_lg_u32 s50, 0
    s_cbranch_scc1 gemm1_kernel_loop

    s_mov_b32 s24, s10
    s_mov_b32 s25, s11
    s_and_b32 s25, s25, 0xffff
    s_mov_b32 s26, 0x1c00
    s_mov_b32 s27, 0x20000
    s_add_u32 s28, s4, 0xc00000
    s_addc_u32 s29, s5, 0
    s_and_b32 s29, s29, 0xffff
    s_mov_b32 s30, 0x700000
    s_mov_b32 s31, 0x20000
    s_lshl_b32 s43, s39, 6
    s_add_u32 s43, s43, s36
    v_add_u32 v4, s43, v3
    v_lshlrev_b32 v5, 1, v4

    buffer_load_ushort v10, v5, s[24:27], 0 offen offset:0
    buffer_load_ushort v11, v5, s[24:27], 0 offen offset:32
    s_lshr_b32 s44, s43, 6
    s_lshl_b32 s44, s44, 17
    s_lshl_b32 s45, s35, 7
    s_add_u32 s44, s44, s45
    s_lshl_b32 s45, s38, 7
    s_add_u32 s44, s44, s45
    v_lshlrev_b32 v6, 3, v2
    v_lshl_add_u32 v6, v3, 8, v6
    v_add_u32 v8, s44, v6

    s_waitcnt lgkmcnt(0)
    v_mfma_f32_16x16x32_bf16 v[32:35], v[96:99], v[112:115], v[32:35]
    ds_read_b64_tr_b16 v[128:129], v16 offset:8192
    ds_read_b64_tr_b16 v[130:131], v16 offset:12288
    v_mfma_f32_16x16x32_bf16 v[36:39], v[100:103], v[112:115], v[36:39]
    ds_read_b64_tr_b16 v[132:133], v17 offset:8192
    ds_read_b64_tr_b16 v[134:135], v17 offset:12288
    v_mfma_f32_16x16x32_bf16 v[40:43], v[104:107], v[112:115], v[40:43]
    ds_read_b64_tr_b16 v[136:137], v18 offset:8192
    ds_read_b64_tr_b16 v[138:139], v18 offset:12288
    v_mfma_f32_16x16x32_bf16 v[44:47], v[108:111], v[112:115], v[44:47]
    ds_read_b64_tr_b16 v[140:141], v19 offset:8192
    ds_read_b64_tr_b16 v[142:143], v19 offset:12288
    v_mfma_f32_16x16x32_bf16 v[48:51], v[96:99], v[116:119], v[48:51]
    ds_read_b64_tr_b16 v[144:145], v24 offset:24576
    ds_read_b64_tr_b16 v[146:147], v24 offset:28672
    v_mfma_f32_16x16x32_bf16 v[52:55], v[100:103], v[116:119], v[52:55]
    ds_read_b64_tr_b16 v[148:149], v25 offset:24576
    ds_read_b64_tr_b16 v[150:151], v25 offset:28672
    v_mfma_f32_16x16x32_bf16 v[56:59], v[104:107], v[116:119], v[56:59]
    ds_read_b64_tr_b16 v[152:153], v26 offset:24576
    ds_read_b64_tr_b16 v[154:155], v26 offset:28672
    v_mfma_f32_16x16x32_bf16 v[60:63], v[108:111], v[116:119], v[60:63]
    ds_read_b64_tr_b16 v[156:157], v27 offset:24576
    ds_read_b64_tr_b16 v[158:159], v27 offset:28672
    v_mfma_f32_16x16x32_bf16 v[64:67], v[96:99], v[120:123], v[64:67]
    v_mfma_f32_16x16x32_bf16 v[68:71], v[100:103], v[120:123], v[68:71]
    v_mfma_f32_16x16x32_bf16 v[72:75], v[104:107], v[120:123], v[72:75]
    v_mfma_f32_16x16x32_bf16 v[76:79], v[108:111], v[120:123], v[76:79]
    v_mfma_f32_16x16x32_bf16 v[80:83], v[96:99], v[124:127], v[80:83]
    v_mfma_f32_16x16x32_bf16 v[84:87], v[100:103], v[124:127], v[84:87]
    v_mfma_f32_16x16x32_bf16 v[88:91], v[104:107], v[124:127], v[88:91]
    v_mfma_f32_16x16x32_bf16 v[92:95], v[108:111], v[124:127], v[92:95]
    s_waitcnt lgkmcnt(0)
    s_barrier
    v_mfma_f32_16x16x32_bf16 v[32:35], v[128:131], v[144:147], v[32:35]
    ds_read_b64_tr_b16 v[96:97], v16 offset:32768
    ds_read_b64_tr_b16 v[98:99], v16 offset:36864
    v_mfma_f32_16x16x32_bf16 v[36:39], v[132:135], v[144:147], v[36:39]
    ds_read_b64_tr_b16 v[100:101], v17 offset:32768
    ds_read_b64_tr_b16 v[102:103], v17 offset:36864
    v_mfma_f32_16x16x32_bf16 v[40:43], v[136:139], v[144:147], v[40:43]
    ds_read_b64_tr_b16 v[104:105], v18 offset:32768
    ds_read_b64_tr_b16 v[106:107], v18 offset:36864
    v_mfma_f32_16x16x32_bf16 v[44:47], v[140:143], v[144:147], v[44:47]
    ds_read_b64_tr_b16 v[108:109], v19 offset:32768
    ds_read_b64_tr_b16 v[110:111], v19 offset:36864
    v_mfma_f32_16x16x32_bf16 v[48:51], v[128:131], v[148:151], v[48:51]
    ds_read_b64_tr_b16 v[112:113], v24 offset:49152
    ds_read_b64_tr_b16 v[114:115], v24 offset:53248
    v_mfma_f32_16x16x32_bf16 v[52:55], v[132:135], v[148:151], v[52:55]
    ds_read_b64_tr_b16 v[116:117], v25 offset:49152
    ds_read_b64_tr_b16 v[118:119], v25 offset:53248
    v_mfma_f32_16x16x32_bf16 v[56:59], v[136:139], v[148:151], v[56:59]
    ds_read_b64_tr_b16 v[120:121], v26 offset:49152
    ds_read_b64_tr_b16 v[122:123], v26 offset:53248
    v_mfma_f32_16x16x32_bf16 v[60:63], v[140:143], v[148:151], v[60:63]
    ds_read_b64_tr_b16 v[124:125], v27 offset:49152
    ds_read_b64_tr_b16 v[126:127], v27 offset:53248
    v_mfma_f32_16x16x32_bf16 v[64:67], v[128:131], v[152:155], v[64:67]
    v_mfma_f32_16x16x32_bf16 v[68:71], v[132:135], v[152:155], v[68:71]
    v_mfma_f32_16x16x32_bf16 v[72:75], v[136:139], v[152:155], v[72:75]
    v_mfma_f32_16x16x32_bf16 v[76:79], v[140:143], v[152:155], v[76:79]
    v_mfma_f32_16x16x32_bf16 v[80:83], v[128:131], v[156:159], v[80:83]
    v_mfma_f32_16x16x32_bf16 v[84:87], v[132:135], v[156:159], v[84:87]
    v_mfma_f32_16x16x32_bf16 v[88:91], v[136:139], v[156:159], v[88:91]
    v_mfma_f32_16x16x32_bf16 v[92:95], v[140:143], v[156:159], v[92:95]
    s_waitcnt lgkmcnt(0)
    v_mfma_f32_16x16x32_bf16 v[32:35], v[96:99], v[112:115], v[32:35]
    ds_read_b64_tr_b16 v[128:129], v16 offset:40960
    ds_read_b64_tr_b16 v[130:131], v16 offset:45056
    v_mfma_f32_16x16x32_bf16 v[36:39], v[100:103], v[112:115], v[36:39]
    ds_read_b64_tr_b16 v[132:133], v17 offset:40960
    ds_read_b64_tr_b16 v[134:135], v17 offset:45056
    v_mfma_f32_16x16x32_bf16 v[40:43], v[104:107], v[112:115], v[40:43]
    ds_read_b64_tr_b16 v[136:137], v18 offset:40960
    ds_read_b64_tr_b16 v[138:139], v18 offset:45056
    v_mfma_f32_16x16x32_bf16 v[44:47], v[108:111], v[112:115], v[44:47]
    ds_read_b64_tr_b16 v[140:141], v19 offset:40960
    ds_read_b64_tr_b16 v[142:143], v19 offset:45056
    v_mfma_f32_16x16x32_bf16 v[48:51], v[96:99], v[116:119], v[48:51]
    ds_read_b64_tr_b16 v[144:145], v24 offset:57344
    ds_read_b64_tr_b16 v[146:147], v24 offset:61440
    v_mfma_f32_16x16x32_bf16 v[52:55], v[100:103], v[116:119], v[52:55]
    ds_read_b64_tr_b16 v[148:149], v25 offset:57344
    ds_read_b64_tr_b16 v[150:151], v25 offset:61440
    v_mfma_f32_16x16x32_bf16 v[56:59], v[104:107], v[116:119], v[56:59]
    ds_read_b64_tr_b16 v[152:153], v26 offset:57344
    ds_read_b64_tr_b16 v[154:155], v26 offset:61440
    v_mfma_f32_16x16x32_bf16 v[60:63], v[108:111], v[116:119], v[60:63]
    ds_read_b64_tr_b16 v[156:157], v27 offset:57344
    ds_read_b64_tr_b16 v[158:159], v27 offset:61440
    v_mfma_f32_16x16x32_bf16 v[64:67], v[96:99], v[120:123], v[64:67]
    v_mfma_f32_16x16x32_bf16 v[68:71], v[100:103], v[120:123], v[68:71]
    v_mfma_f32_16x16x32_bf16 v[72:75], v[104:107], v[120:123], v[72:75]
    v_mfma_f32_16x16x32_bf16 v[76:79], v[108:111], v[120:123], v[76:79]
    v_mfma_f32_16x16x32_bf16 v[80:83], v[96:99], v[124:127], v[80:83]
    v_mfma_f32_16x16x32_bf16 v[84:87], v[100:103], v[124:127], v[84:87]
    v_mfma_f32_16x16x32_bf16 v[88:91], v[104:107], v[124:127], v[88:91]
    v_mfma_f32_16x16x32_bf16 v[92:95], v[108:111], v[124:127], v[92:95]
    s_waitcnt lgkmcnt(0)
    s_barrier
    v_mfma_f32_16x16x32_bf16 v[32:35], v[128:131], v[144:147], v[32:35]
    ds_read_b64_tr_b16 v[96:97], v20 offset:0
    ds_read_b64_tr_b16 v[98:99], v20 offset:4096
    v_mfma_f32_16x16x32_bf16 v[36:39], v[132:135], v[144:147], v[36:39]
    ds_read_b64_tr_b16 v[100:101], v21 offset:0
    ds_read_b64_tr_b16 v[102:103], v21 offset:4096
    v_mfma_f32_16x16x32_bf16 v[40:43], v[136:139], v[144:147], v[40:43]
    ds_read_b64_tr_b16 v[104:105], v22 offset:0
    ds_read_b64_tr_b16 v[106:107], v22 offset:4096
    v_mfma_f32_16x16x32_bf16 v[44:47], v[140:143], v[144:147], v[44:47]
    ds_read_b64_tr_b16 v[108:109], v23 offset:0
    ds_read_b64_tr_b16 v[110:111], v23 offset:4096
    v_mfma_f32_16x16x32_bf16 v[48:51], v[128:131], v[148:151], v[48:51]
    ds_read_b64_tr_b16 v[112:113], v28 offset:16384
    ds_read_b64_tr_b16 v[114:115], v28 offset:20480
    v_mfma_f32_16x16x32_bf16 v[52:55], v[132:135], v[148:151], v[52:55]
    ds_read_b64_tr_b16 v[116:117], v29 offset:16384
    ds_read_b64_tr_b16 v[118:119], v29 offset:20480
    v_mfma_f32_16x16x32_bf16 v[56:59], v[136:139], v[148:151], v[56:59]
    ds_read_b64_tr_b16 v[120:121], v30 offset:16384
    ds_read_b64_tr_b16 v[122:123], v30 offset:20480
    v_mfma_f32_16x16x32_bf16 v[60:63], v[140:143], v[148:151], v[60:63]
    ds_read_b64_tr_b16 v[124:125], v31 offset:16384
    ds_read_b64_tr_b16 v[126:127], v31 offset:20480
    v_mfma_f32_16x16x32_bf16 v[64:67], v[128:131], v[152:155], v[64:67]
    v_mfma_f32_16x16x32_bf16 v[68:71], v[132:135], v[152:155], v[68:71]
    v_mfma_f32_16x16x32_bf16 v[72:75], v[136:139], v[152:155], v[72:75]
    v_mfma_f32_16x16x32_bf16 v[76:79], v[140:143], v[152:155], v[76:79]
    v_mfma_f32_16x16x32_bf16 v[80:83], v[128:131], v[156:159], v[80:83]
    v_mfma_f32_16x16x32_bf16 v[84:87], v[132:135], v[156:159], v[84:87]
    v_mfma_f32_16x16x32_bf16 v[88:91], v[136:139], v[156:159], v[88:91]
    v_mfma_f32_16x16x32_bf16 v[92:95], v[140:143], v[156:159], v[92:95]
    s_waitcnt lgkmcnt(0)
    v_mfma_f32_16x16x32_bf16 v[32:35], v[96:99], v[112:115], v[32:35]
    ds_read_b64_tr_b16 v[128:129], v20 offset:8192
    ds_read_b64_tr_b16 v[130:131], v20 offset:12288
    v_mfma_f32_16x16x32_bf16 v[36:39], v[100:103], v[112:115], v[36:39]
    ds_read_b64_tr_b16 v[132:133], v21 offset:8192
    ds_read_b64_tr_b16 v[134:135], v21 offset:12288
    v_mfma_f32_16x16x32_bf16 v[40:43], v[104:107], v[112:115], v[40:43]
    ds_read_b64_tr_b16 v[136:137], v22 offset:8192
    ds_read_b64_tr_b16 v[138:139], v22 offset:12288
    v_mfma_f32_16x16x32_bf16 v[44:47], v[108:111], v[112:115], v[44:47]
    ds_read_b64_tr_b16 v[140:141], v23 offset:8192
    ds_read_b64_tr_b16 v[142:143], v23 offset:12288
    v_mfma_f32_16x16x32_bf16 v[48:51], v[96:99], v[116:119], v[48:51]
    ds_read_b64_tr_b16 v[144:145], v28 offset:24576
    ds_read_b64_tr_b16 v[146:147], v28 offset:28672
    v_mfma_f32_16x16x32_bf16 v[52:55], v[100:103], v[116:119], v[52:55]
    ds_read_b64_tr_b16 v[148:149], v29 offset:24576
    ds_read_b64_tr_b16 v[150:151], v29 offset:28672
    v_mfma_f32_16x16x32_bf16 v[56:59], v[104:107], v[116:119], v[56:59]
    ds_read_b64_tr_b16 v[152:153], v30 offset:24576
    ds_read_b64_tr_b16 v[154:155], v30 offset:28672
    v_mfma_f32_16x16x32_bf16 v[60:63], v[108:111], v[116:119], v[60:63]
    ds_read_b64_tr_b16 v[156:157], v31 offset:24576
    ds_read_b64_tr_b16 v[158:159], v31 offset:28672
    v_mfma_f32_16x16x32_bf16 v[64:67], v[96:99], v[120:123], v[64:67]
    v_mfma_f32_16x16x32_bf16 v[68:71], v[100:103], v[120:123], v[68:71]
    v_mfma_f32_16x16x32_bf16 v[72:75], v[104:107], v[120:123], v[72:75]
    v_mfma_f32_16x16x32_bf16 v[76:79], v[108:111], v[120:123], v[76:79]
    v_mfma_f32_16x16x32_bf16 v[80:83], v[96:99], v[124:127], v[80:83]
    v_mfma_f32_16x16x32_bf16 v[84:87], v[100:103], v[124:127], v[84:87]
    v_mfma_f32_16x16x32_bf16 v[88:91], v[104:107], v[124:127], v[88:91]
    v_mfma_f32_16x16x32_bf16 v[92:95], v[108:111], v[124:127], v[92:95]
    s_waitcnt lgkmcnt(0)
    s_barrier
    v_mfma_f32_16x16x32_bf16 v[32:35], v[128:131], v[144:147], v[32:35]
    ds_read_b64_tr_b16 v[96:97], v16 offset:0
    ds_read_b64_tr_b16 v[98:99], v16 offset:4096
    v_mfma_f32_16x16x32_bf16 v[36:39], v[132:135], v[144:147], v[36:39]
    ds_read_b64_tr_b16 v[100:101], v17 offset:0
    ds_read_b64_tr_b16 v[102:103], v17 offset:4096
    v_mfma_f32_16x16x32_bf16 v[40:43], v[136:139], v[144:147], v[40:43]
    ds_read_b64_tr_b16 v[104:105], v18 offset:0
    ds_read_b64_tr_b16 v[106:107], v18 offset:4096
    v_mfma_f32_16x16x32_bf16 v[44:47], v[140:143], v[144:147], v[44:47]
    ds_read_b64_tr_b16 v[108:109], v19 offset:0
    ds_read_b64_tr_b16 v[110:111], v19 offset:4096
    v_mfma_f32_16x16x32_bf16 v[48:51], v[128:131], v[148:151], v[48:51]
    ds_read_b64_tr_b16 v[112:113], v24 offset:16384
    ds_read_b64_tr_b16 v[114:115], v24 offset:20480
    v_mfma_f32_16x16x32_bf16 v[52:55], v[132:135], v[148:151], v[52:55]
    ds_read_b64_tr_b16 v[116:117], v25 offset:16384
    ds_read_b64_tr_b16 v[118:119], v25 offset:20480
    v_mfma_f32_16x16x32_bf16 v[56:59], v[136:139], v[148:151], v[56:59]
    ds_read_b64_tr_b16 v[120:121], v26 offset:16384
    ds_read_b64_tr_b16 v[122:123], v26 offset:20480
    v_mfma_f32_16x16x32_bf16 v[60:63], v[140:143], v[148:151], v[60:63]
    ds_read_b64_tr_b16 v[124:125], v27 offset:16384
    ds_read_b64_tr_b16 v[126:127], v27 offset:20480
    v_mfma_f32_16x16x32_bf16 v[64:67], v[128:131], v[152:155], v[64:67]
    v_mfma_f32_16x16x32_bf16 v[68:71], v[132:135], v[152:155], v[68:71]
    v_mfma_f32_16x16x32_bf16 v[72:75], v[136:139], v[152:155], v[72:75]
    v_mfma_f32_16x16x32_bf16 v[76:79], v[140:143], v[152:155], v[76:79]
    v_mfma_f32_16x16x32_bf16 v[80:83], v[128:131], v[156:159], v[80:83]
    v_mfma_f32_16x16x32_bf16 v[84:87], v[132:135], v[156:159], v[84:87]
    v_mfma_f32_16x16x32_bf16 v[88:91], v[136:139], v[156:159], v[88:91]
    v_mfma_f32_16x16x32_bf16 v[92:95], v[140:143], v[156:159], v[92:95]
    s_waitcnt lgkmcnt(0)
    v_mfma_f32_16x16x32_bf16 v[32:35], v[96:99], v[112:115], v[32:35]
    ds_read_b64_tr_b16 v[128:129], v16 offset:8192
    ds_read_b64_tr_b16 v[130:131], v16 offset:12288
    v_mfma_f32_16x16x32_bf16 v[36:39], v[100:103], v[112:115], v[36:39]
    ds_read_b64_tr_b16 v[132:133], v17 offset:8192
    ds_read_b64_tr_b16 v[134:135], v17 offset:12288
    v_mfma_f32_16x16x32_bf16 v[40:43], v[104:107], v[112:115], v[40:43]
    ds_read_b64_tr_b16 v[136:137], v18 offset:8192
    ds_read_b64_tr_b16 v[138:139], v18 offset:12288
    v_mfma_f32_16x16x32_bf16 v[44:47], v[108:111], v[112:115], v[44:47]
    ds_read_b64_tr_b16 v[140:141], v19 offset:8192
    ds_read_b64_tr_b16 v[142:143], v19 offset:12288
    v_mfma_f32_16x16x32_bf16 v[48:51], v[96:99], v[116:119], v[48:51]
    ds_read_b64_tr_b16 v[144:145], v24 offset:24576
    ds_read_b64_tr_b16 v[146:147], v24 offset:28672
    v_mfma_f32_16x16x32_bf16 v[52:55], v[100:103], v[116:119], v[52:55]
    ds_read_b64_tr_b16 v[148:149], v25 offset:24576
    ds_read_b64_tr_b16 v[150:151], v25 offset:28672
    v_mfma_f32_16x16x32_bf16 v[56:59], v[104:107], v[116:119], v[56:59]
    ds_read_b64_tr_b16 v[152:153], v26 offset:24576
    ds_read_b64_tr_b16 v[154:155], v26 offset:28672
    v_mfma_f32_16x16x32_bf16 v[60:63], v[108:111], v[116:119], v[60:63]
    ds_read_b64_tr_b16 v[156:157], v27 offset:24576
    ds_read_b64_tr_b16 v[158:159], v27 offset:28672
    v_mfma_f32_16x16x32_bf16 v[64:67], v[96:99], v[120:123], v[64:67]
    v_mfma_f32_16x16x32_bf16 v[68:71], v[100:103], v[120:123], v[68:71]
    v_mfma_f32_16x16x32_bf16 v[72:75], v[104:107], v[120:123], v[72:75]
    v_mfma_f32_16x16x32_bf16 v[76:79], v[108:111], v[120:123], v[76:79]
    v_mfma_f32_16x16x32_bf16 v[80:83], v[96:99], v[124:127], v[80:83]
    v_mfma_f32_16x16x32_bf16 v[84:87], v[100:103], v[124:127], v[84:87]
    v_mfma_f32_16x16x32_bf16 v[88:91], v[104:107], v[124:127], v[88:91]
    v_mfma_f32_16x16x32_bf16 v[92:95], v[108:111], v[124:127], v[92:95]
    s_waitcnt lgkmcnt(0)
    s_barrier
    v_mfma_f32_16x16x32_bf16 v[32:35], v[128:131], v[144:147], v[32:35]
    ds_read_b64_tr_b16 v[96:97], v16 offset:32768
    ds_read_b64_tr_b16 v[98:99], v16 offset:36864
    v_mfma_f32_16x16x32_bf16 v[36:39], v[132:135], v[144:147], v[36:39]
    ds_read_b64_tr_b16 v[100:101], v17 offset:32768
    ds_read_b64_tr_b16 v[102:103], v17 offset:36864
    v_mfma_f32_16x16x32_bf16 v[40:43], v[136:139], v[144:147], v[40:43]
    ds_read_b64_tr_b16 v[104:105], v18 offset:32768
    ds_read_b64_tr_b16 v[106:107], v18 offset:36864
    v_mfma_f32_16x16x32_bf16 v[44:47], v[140:143], v[144:147], v[44:47]
    ds_read_b64_tr_b16 v[108:109], v19 offset:32768
    ds_read_b64_tr_b16 v[110:111], v19 offset:36864
    v_mfma_f32_16x16x32_bf16 v[48:51], v[128:131], v[148:151], v[48:51]
    ds_read_b64_tr_b16 v[112:113], v24 offset:49152
    ds_read_b64_tr_b16 v[114:115], v24 offset:53248
    v_mfma_f32_16x16x32_bf16 v[52:55], v[132:135], v[148:151], v[52:55]
    ds_read_b64_tr_b16 v[116:117], v25 offset:49152
    ds_read_b64_tr_b16 v[118:119], v25 offset:53248
    v_mfma_f32_16x16x32_bf16 v[56:59], v[136:139], v[148:151], v[56:59]
    ds_read_b64_tr_b16 v[120:121], v26 offset:49152
    ds_read_b64_tr_b16 v[122:123], v26 offset:53248
    v_mfma_f32_16x16x32_bf16 v[60:63], v[140:143], v[148:151], v[60:63]
    ds_read_b64_tr_b16 v[124:125], v27 offset:49152
    ds_read_b64_tr_b16 v[126:127], v27 offset:53248
    v_mfma_f32_16x16x32_bf16 v[64:67], v[128:131], v[152:155], v[64:67]
    v_mfma_f32_16x16x32_bf16 v[68:71], v[132:135], v[152:155], v[68:71]
    v_mfma_f32_16x16x32_bf16 v[72:75], v[136:139], v[152:155], v[72:75]
    v_mfma_f32_16x16x32_bf16 v[76:79], v[140:143], v[152:155], v[76:79]
    v_mfma_f32_16x16x32_bf16 v[80:83], v[128:131], v[156:159], v[80:83]
    v_mfma_f32_16x16x32_bf16 v[84:87], v[132:135], v[156:159], v[84:87]
    v_mfma_f32_16x16x32_bf16 v[88:91], v[136:139], v[156:159], v[88:91]
    v_mfma_f32_16x16x32_bf16 v[92:95], v[140:143], v[156:159], v[92:95]
    s_waitcnt lgkmcnt(0)
    v_mfma_f32_16x16x32_bf16 v[32:35], v[96:99], v[112:115], v[32:35]
    ds_read_b64_tr_b16 v[128:129], v16 offset:40960
    ds_read_b64_tr_b16 v[130:131], v16 offset:45056
    v_mfma_f32_16x16x32_bf16 v[36:39], v[100:103], v[112:115], v[36:39]
    ds_read_b64_tr_b16 v[132:133], v17 offset:40960
    ds_read_b64_tr_b16 v[134:135], v17 offset:45056
    v_mfma_f32_16x16x32_bf16 v[40:43], v[104:107], v[112:115], v[40:43]
    ds_read_b64_tr_b16 v[136:137], v18 offset:40960
    ds_read_b64_tr_b16 v[138:139], v18 offset:45056
    v_mfma_f32_16x16x32_bf16 v[44:47], v[108:111], v[112:115], v[44:47]
    ds_read_b64_tr_b16 v[140:141], v19 offset:40960
    ds_read_b64_tr_b16 v[142:143], v19 offset:45056
    v_mfma_f32_16x16x32_bf16 v[48:51], v[96:99], v[116:119], v[48:51]
    ds_read_b64_tr_b16 v[144:145], v24 offset:57344
    ds_read_b64_tr_b16 v[146:147], v24 offset:61440
    v_mfma_f32_16x16x32_bf16 v[52:55], v[100:103], v[116:119], v[52:55]
    ds_read_b64_tr_b16 v[148:149], v25 offset:57344
    ds_read_b64_tr_b16 v[150:151], v25 offset:61440
    v_mfma_f32_16x16x32_bf16 v[56:59], v[104:107], v[116:119], v[56:59]
    ds_read_b64_tr_b16 v[152:153], v26 offset:57344
    ds_read_b64_tr_b16 v[154:155], v26 offset:61440
    v_mfma_f32_16x16x32_bf16 v[60:63], v[108:111], v[116:119], v[60:63]
    ds_read_b64_tr_b16 v[156:157], v27 offset:57344
    ds_read_b64_tr_b16 v[158:159], v27 offset:61440
    v_mfma_f32_16x16x32_bf16 v[64:67], v[96:99], v[120:123], v[64:67]
    v_mfma_f32_16x16x32_bf16 v[68:71], v[100:103], v[120:123], v[68:71]
    v_mfma_f32_16x16x32_bf16 v[72:75], v[104:107], v[120:123], v[72:75]
    v_mfma_f32_16x16x32_bf16 v[76:79], v[108:111], v[120:123], v[76:79]
    v_mfma_f32_16x16x32_bf16 v[80:83], v[96:99], v[124:127], v[80:83]
    v_mfma_f32_16x16x32_bf16 v[84:87], v[100:103], v[124:127], v[84:87]
    v_mfma_f32_16x16x32_bf16 v[88:91], v[104:107], v[124:127], v[88:91]
    v_mfma_f32_16x16x32_bf16 v[92:95], v[108:111], v[124:127], v[92:95]
    s_waitcnt lgkmcnt(0)
    v_mfma_f32_16x16x32_bf16 v[32:35], v[128:131], v[144:147], v[32:35]
    v_mfma_f32_16x16x32_bf16 v[36:39], v[132:135], v[144:147], v[36:39]
    v_mfma_f32_16x16x32_bf16 v[40:43], v[136:139], v[144:147], v[40:43]
    v_mfma_f32_16x16x32_bf16 v[44:47], v[140:143], v[144:147], v[44:47]
    v_mfma_f32_16x16x32_bf16 v[48:51], v[128:131], v[148:151], v[48:51]
    v_mfma_f32_16x16x32_bf16 v[52:55], v[132:135], v[148:151], v[52:55]
    v_mfma_f32_16x16x32_bf16 v[56:59], v[136:139], v[148:151], v[56:59]
    v_mfma_f32_16x16x32_bf16 v[60:63], v[140:143], v[148:151], v[60:63]
    v_mfma_f32_16x16x32_bf16 v[64:67], v[128:131], v[152:155], v[64:67]
    v_mfma_f32_16x16x32_bf16 v[68:71], v[132:135], v[152:155], v[68:71]
    v_mfma_f32_16x16x32_bf16 v[72:75], v[136:139], v[152:155], v[72:75]
    v_mfma_f32_16x16x32_bf16 v[76:79], v[140:143], v[152:155], v[76:79]
    v_mfma_f32_16x16x32_bf16 v[80:83], v[128:131], v[156:159], v[80:83]
    v_mfma_f32_16x16x32_bf16 v[84:87], v[132:135], v[156:159], v[84:87]
    v_mfma_f32_16x16x32_bf16 v[88:91], v[136:139], v[156:159], v[88:91]
    v_mfma_f32_16x16x32_bf16 v[92:95], v[140:143], v[156:159], v[92:95]
    s_nop 7
    s_nop 7
    s_mul_i32 s43, s32, 8192
    s_add_u32 s43, s43, 0
    v_lshlrev_b32 v15, 4, v0
    v_add_u32 v15, s43, v15

    ds_write_b128 v15, v[64:67] offset:0
    ds_write_b128 v15, v[68:71] offset:1024
    ds_write_b128 v15, v[72:75] offset:2048
    ds_write_b128 v15, v[76:79] offset:3072
    ds_write_b128 v15, v[80:83] offset:4096
    ds_write_b128 v15, v[84:87] offset:5120
    ds_write_b128 v15, v[88:91] offset:6144
    ds_write_b128 v15, v[92:95] offset:7168
    s_waitcnt lgkmcnt(0)
    s_barrier
    v_mov_b32 v1, 0xffff0000
    s_waitcnt vmcnt(0)

    v_mov_b32 v108, 0x3dd2d3e8
    v_mov_b32 v109, 0x3dd2d3e8
    v_mov_b32 v110, 0x40135761
    v_mov_b32 v111, 0x40135761
    v_mov_b32 v112, 1.0
    v_mov_b32 v113, 1.0

    v_lshlrev_b32 v114, 16, v10
    v_lshlrev_b32 v115, 16, v10
    v_add_u32 v7, 0, v8
    v_cvt_pk_bf16_f32 v96, v32, v33
    v_cvt_pk_bf16_f32 v97, v34, v35
    v_lshlrev_b32 v32, 16, v96
    v_lshlrev_b32 v34, 16, v97
    v_and_b32 v33, v1, v96
    v_and_b32 v35, v1, v97
    v_pk_add_f32 v[32:33], v[32:33], v[114:115]
    v_pk_add_f32 v[34:35], v[34:35], v[114:115]
    v_cvt_pk_bf16_f32 v96, v32, v33
    v_cvt_pk_bf16_f32 v97, v34, v35
    v_lshlrev_b32 v32, 16, v96
    v_lshlrev_b32 v34, 16, v97
    v_and_b32 v33, v1, v96
    v_and_b32 v35, v1, v97
    v_pk_mul_f32 v[98:99], v[32:33], v[32:33]
    v_pk_mul_f32 v[100:101], v[34:35], v[34:35]
    v_pk_fma_f32 v[98:99], v[98:99], v[108:109], v[110:111]
    v_pk_fma_f32 v[100:101], v[100:101], v[108:109], v[110:111]
    v_pk_mul_f32 v[98:99], v[98:99], v[32:33]
    v_pk_mul_f32 v[100:101], v[100:101], v[34:35]
    v_exp_f32 v98, v98
    v_exp_f32 v100, v100
    v_exp_f32 v99, v99
    v_exp_f32 v101, v101
    v_pk_add_f32 v[98:99], v[98:99], v[112:113]
    v_pk_add_f32 v[100:101], v[100:101], v[112:113]
    v_rcp_f32 v98, v98
    v_rcp_f32 v100, v100
    v_rcp_f32 v99, v99
    v_rcp_f32 v101, v101
    v_pk_fma_f32 v[32:33], v[32:33], v[98:99], v[32:33] neg_lo:[1,0,0] neg_hi:[1,0,0]
    v_pk_fma_f32 v[34:35], v[34:35], v[100:101], v[34:35] neg_lo:[1,0,0] neg_hi:[1,0,0]
    v_cvt_pk_bf16_f32 v104, v32, v33
    v_cvt_pk_bf16_f32 v105, v34, v35
    buffer_store_dwordx2 v[104:105], v7, s[28:31], 0 offen offset:0
    v_cvt_pk_bf16_f32 v96, v36, v37
    v_cvt_pk_bf16_f32 v97, v38, v39
    v_lshlrev_b32 v36, 16, v96
    v_lshlrev_b32 v38, 16, v97
    v_and_b32 v37, v1, v96
    v_and_b32 v39, v1, v97
    v_pk_add_f32 v[36:37], v[36:37], v[114:115]
    v_pk_add_f32 v[38:39], v[38:39], v[114:115]
    v_cvt_pk_bf16_f32 v96, v36, v37
    v_cvt_pk_bf16_f32 v97, v38, v39
    v_lshlrev_b32 v36, 16, v96
    v_lshlrev_b32 v38, 16, v97
    v_and_b32 v37, v1, v96
    v_and_b32 v39, v1, v97
    v_pk_mul_f32 v[98:99], v[36:37], v[36:37]
    v_pk_mul_f32 v[100:101], v[38:39], v[38:39]
    v_pk_fma_f32 v[98:99], v[98:99], v[108:109], v[110:111]
    v_pk_fma_f32 v[100:101], v[100:101], v[108:109], v[110:111]
    v_pk_mul_f32 v[98:99], v[98:99], v[36:37]
    v_pk_mul_f32 v[100:101], v[100:101], v[38:39]
    v_exp_f32 v98, v98
    v_exp_f32 v100, v100
    v_exp_f32 v99, v99
    v_exp_f32 v101, v101
    v_pk_add_f32 v[98:99], v[98:99], v[112:113]
    v_pk_add_f32 v[100:101], v[100:101], v[112:113]
    v_rcp_f32 v98, v98
    v_rcp_f32 v100, v100
    v_rcp_f32 v99, v99
    v_rcp_f32 v101, v101
    v_pk_fma_f32 v[36:37], v[36:37], v[98:99], v[36:37] neg_lo:[1,0,0] neg_hi:[1,0,0]
    v_pk_fma_f32 v[38:39], v[38:39], v[100:101], v[38:39] neg_lo:[1,0,0] neg_hi:[1,0,0]
    v_cvt_pk_bf16_f32 v106, v36, v37
    v_cvt_pk_bf16_f32 v107, v38, v39
    buffer_store_dwordx2 v[106:107], v7, s[28:31], 0 offen offset:32
    v_cvt_pk_bf16_f32 v96, v40, v41
    v_cvt_pk_bf16_f32 v97, v42, v43
    v_lshlrev_b32 v40, 16, v96
    v_lshlrev_b32 v42, 16, v97
    v_and_b32 v41, v1, v96
    v_and_b32 v43, v1, v97
    v_pk_add_f32 v[40:41], v[40:41], v[114:115]
    v_pk_add_f32 v[42:43], v[42:43], v[114:115]
    v_cvt_pk_bf16_f32 v96, v40, v41
    v_cvt_pk_bf16_f32 v97, v42, v43
    v_lshlrev_b32 v40, 16, v96
    v_lshlrev_b32 v42, 16, v97
    v_and_b32 v41, v1, v96
    v_and_b32 v43, v1, v97
    v_pk_mul_f32 v[98:99], v[40:41], v[40:41]
    v_pk_mul_f32 v[100:101], v[42:43], v[42:43]
    v_pk_fma_f32 v[98:99], v[98:99], v[108:109], v[110:111]
    v_pk_fma_f32 v[100:101], v[100:101], v[108:109], v[110:111]
    v_pk_mul_f32 v[98:99], v[98:99], v[40:41]
    v_pk_mul_f32 v[100:101], v[100:101], v[42:43]
    v_exp_f32 v98, v98
    v_exp_f32 v100, v100
    v_exp_f32 v99, v99
    v_exp_f32 v101, v101
    v_pk_add_f32 v[98:99], v[98:99], v[112:113]
    v_pk_add_f32 v[100:101], v[100:101], v[112:113]
    v_rcp_f32 v98, v98
    v_rcp_f32 v100, v100
    v_rcp_f32 v99, v99
    v_rcp_f32 v101, v101
    v_pk_fma_f32 v[40:41], v[40:41], v[98:99], v[40:41] neg_lo:[1,0,0] neg_hi:[1,0,0]
    v_pk_fma_f32 v[42:43], v[42:43], v[100:101], v[42:43] neg_lo:[1,0,0] neg_hi:[1,0,0]
    v_cvt_pk_bf16_f32 v104, v40, v41
    v_cvt_pk_bf16_f32 v105, v42, v43
    buffer_store_dwordx2 v[104:105], v7, s[28:31], 0 offen offset:64
    v_cvt_pk_bf16_f32 v96, v44, v45
    v_cvt_pk_bf16_f32 v97, v46, v47
    v_lshlrev_b32 v44, 16, v96
    v_lshlrev_b32 v46, 16, v97
    v_and_b32 v45, v1, v96
    v_and_b32 v47, v1, v97
    v_pk_add_f32 v[44:45], v[44:45], v[114:115]
    v_pk_add_f32 v[46:47], v[46:47], v[114:115]
    v_cvt_pk_bf16_f32 v96, v44, v45
    v_cvt_pk_bf16_f32 v97, v46, v47
    v_lshlrev_b32 v44, 16, v96
    v_lshlrev_b32 v46, 16, v97
    v_and_b32 v45, v1, v96
    v_and_b32 v47, v1, v97
    v_pk_mul_f32 v[98:99], v[44:45], v[44:45]
    v_pk_mul_f32 v[100:101], v[46:47], v[46:47]
    v_pk_fma_f32 v[98:99], v[98:99], v[108:109], v[110:111]
    v_pk_fma_f32 v[100:101], v[100:101], v[108:109], v[110:111]
    v_pk_mul_f32 v[98:99], v[98:99], v[44:45]
    v_pk_mul_f32 v[100:101], v[100:101], v[46:47]
    v_exp_f32 v98, v98
    v_exp_f32 v100, v100
    v_exp_f32 v99, v99
    v_exp_f32 v101, v101
    v_pk_add_f32 v[98:99], v[98:99], v[112:113]
    v_pk_add_f32 v[100:101], v[100:101], v[112:113]
    v_rcp_f32 v98, v98
    v_rcp_f32 v100, v100
    v_rcp_f32 v99, v99
    v_rcp_f32 v101, v101
    v_pk_fma_f32 v[44:45], v[44:45], v[98:99], v[44:45] neg_lo:[1,0,0] neg_hi:[1,0,0]
    v_pk_fma_f32 v[46:47], v[46:47], v[100:101], v[46:47] neg_lo:[1,0,0] neg_hi:[1,0,0]
    v_cvt_pk_bf16_f32 v106, v44, v45
    v_cvt_pk_bf16_f32 v107, v46, v47
    buffer_store_dwordx2 v[106:107], v7, s[28:31], 0 offen offset:96
    v_lshlrev_b32 v114, 16, v11
    v_lshlrev_b32 v115, 16, v11
    v_add_u32 v7, 4096, v8
    v_cvt_pk_bf16_f32 v96, v48, v49
    v_cvt_pk_bf16_f32 v97, v50, v51
    v_lshlrev_b32 v48, 16, v96
    v_lshlrev_b32 v50, 16, v97
    v_and_b32 v49, v1, v96
    v_and_b32 v51, v1, v97
    v_pk_add_f32 v[48:49], v[48:49], v[114:115]
    v_pk_add_f32 v[50:51], v[50:51], v[114:115]
    v_cvt_pk_bf16_f32 v96, v48, v49
    v_cvt_pk_bf16_f32 v97, v50, v51
    v_lshlrev_b32 v48, 16, v96
    v_lshlrev_b32 v50, 16, v97
    v_and_b32 v49, v1, v96
    v_and_b32 v51, v1, v97
    v_pk_mul_f32 v[98:99], v[48:49], v[48:49]
    v_pk_mul_f32 v[100:101], v[50:51], v[50:51]
    v_pk_fma_f32 v[98:99], v[98:99], v[108:109], v[110:111]
    v_pk_fma_f32 v[100:101], v[100:101], v[108:109], v[110:111]
    v_pk_mul_f32 v[98:99], v[98:99], v[48:49]
    v_pk_mul_f32 v[100:101], v[100:101], v[50:51]
    v_exp_f32 v98, v98
    v_exp_f32 v100, v100
    v_exp_f32 v99, v99
    v_exp_f32 v101, v101
    v_pk_add_f32 v[98:99], v[98:99], v[112:113]
    v_pk_add_f32 v[100:101], v[100:101], v[112:113]
    v_rcp_f32 v98, v98
    v_rcp_f32 v100, v100
    v_rcp_f32 v99, v99
    v_rcp_f32 v101, v101
    v_pk_fma_f32 v[48:49], v[48:49], v[98:99], v[48:49] neg_lo:[1,0,0] neg_hi:[1,0,0]
    v_pk_fma_f32 v[50:51], v[50:51], v[100:101], v[50:51] neg_lo:[1,0,0] neg_hi:[1,0,0]
    v_cvt_pk_bf16_f32 v104, v48, v49
    v_cvt_pk_bf16_f32 v105, v50, v51
    buffer_store_dwordx2 v[104:105], v7, s[28:31], 0 offen offset:0
    v_cvt_pk_bf16_f32 v96, v52, v53
    v_cvt_pk_bf16_f32 v97, v54, v55
    v_lshlrev_b32 v52, 16, v96
    v_lshlrev_b32 v54, 16, v97
    v_and_b32 v53, v1, v96
    v_and_b32 v55, v1, v97
    v_pk_add_f32 v[52:53], v[52:53], v[114:115]
    v_pk_add_f32 v[54:55], v[54:55], v[114:115]
    v_cvt_pk_bf16_f32 v96, v52, v53
    v_cvt_pk_bf16_f32 v97, v54, v55
    v_lshlrev_b32 v52, 16, v96
    v_lshlrev_b32 v54, 16, v97
    v_and_b32 v53, v1, v96
    v_and_b32 v55, v1, v97
    v_pk_mul_f32 v[98:99], v[52:53], v[52:53]
    v_pk_mul_f32 v[100:101], v[54:55], v[54:55]
    v_pk_fma_f32 v[98:99], v[98:99], v[108:109], v[110:111]
    v_pk_fma_f32 v[100:101], v[100:101], v[108:109], v[110:111]
    v_pk_mul_f32 v[98:99], v[98:99], v[52:53]
    v_pk_mul_f32 v[100:101], v[100:101], v[54:55]
    v_exp_f32 v98, v98
    v_exp_f32 v100, v100
    v_exp_f32 v99, v99
    v_exp_f32 v101, v101
    v_pk_add_f32 v[98:99], v[98:99], v[112:113]
    v_pk_add_f32 v[100:101], v[100:101], v[112:113]
    v_rcp_f32 v98, v98
    v_rcp_f32 v100, v100
    v_rcp_f32 v99, v99
    v_rcp_f32 v101, v101
    v_pk_fma_f32 v[52:53], v[52:53], v[98:99], v[52:53] neg_lo:[1,0,0] neg_hi:[1,0,0]
    v_pk_fma_f32 v[54:55], v[54:55], v[100:101], v[54:55] neg_lo:[1,0,0] neg_hi:[1,0,0]
    v_cvt_pk_bf16_f32 v106, v52, v53
    v_cvt_pk_bf16_f32 v107, v54, v55
    buffer_store_dwordx2 v[106:107], v7, s[28:31], 0 offen offset:32
    v_cvt_pk_bf16_f32 v96, v56, v57
    v_cvt_pk_bf16_f32 v97, v58, v59
    v_lshlrev_b32 v56, 16, v96
    v_lshlrev_b32 v58, 16, v97
    v_and_b32 v57, v1, v96
    v_and_b32 v59, v1, v97
    v_pk_add_f32 v[56:57], v[56:57], v[114:115]
    v_pk_add_f32 v[58:59], v[58:59], v[114:115]
    v_cvt_pk_bf16_f32 v96, v56, v57
    v_cvt_pk_bf16_f32 v97, v58, v59
    v_lshlrev_b32 v56, 16, v96
    v_lshlrev_b32 v58, 16, v97
    v_and_b32 v57, v1, v96
    v_and_b32 v59, v1, v97
    v_pk_mul_f32 v[98:99], v[56:57], v[56:57]
    v_pk_mul_f32 v[100:101], v[58:59], v[58:59]
    v_pk_fma_f32 v[98:99], v[98:99], v[108:109], v[110:111]
    v_pk_fma_f32 v[100:101], v[100:101], v[108:109], v[110:111]
    v_pk_mul_f32 v[98:99], v[98:99], v[56:57]
    v_pk_mul_f32 v[100:101], v[100:101], v[58:59]
    v_exp_f32 v98, v98
    v_exp_f32 v100, v100
    v_exp_f32 v99, v99
    v_exp_f32 v101, v101
    v_pk_add_f32 v[98:99], v[98:99], v[112:113]
    v_pk_add_f32 v[100:101], v[100:101], v[112:113]
    v_rcp_f32 v98, v98
    v_rcp_f32 v100, v100
    v_rcp_f32 v99, v99
    v_rcp_f32 v101, v101
    v_pk_fma_f32 v[56:57], v[56:57], v[98:99], v[56:57] neg_lo:[1,0,0] neg_hi:[1,0,0]
    v_pk_fma_f32 v[58:59], v[58:59], v[100:101], v[58:59] neg_lo:[1,0,0] neg_hi:[1,0,0]
    v_cvt_pk_bf16_f32 v104, v56, v57
    v_cvt_pk_bf16_f32 v105, v58, v59
    buffer_store_dwordx2 v[104:105], v7, s[28:31], 0 offen offset:64
    v_cvt_pk_bf16_f32 v96, v60, v61
    v_cvt_pk_bf16_f32 v97, v62, v63
    v_lshlrev_b32 v60, 16, v96
    v_lshlrev_b32 v62, 16, v97
    v_and_b32 v61, v1, v96
    v_and_b32 v63, v1, v97
    v_pk_add_f32 v[60:61], v[60:61], v[114:115]
    v_pk_add_f32 v[62:63], v[62:63], v[114:115]
    v_cvt_pk_bf16_f32 v96, v60, v61
    v_cvt_pk_bf16_f32 v97, v62, v63
    v_lshlrev_b32 v60, 16, v96
    v_lshlrev_b32 v62, 16, v97
    v_and_b32 v61, v1, v96
    v_and_b32 v63, v1, v97
    v_pk_mul_f32 v[98:99], v[60:61], v[60:61]
    v_pk_mul_f32 v[100:101], v[62:63], v[62:63]
    v_pk_fma_f32 v[98:99], v[98:99], v[108:109], v[110:111]
    v_pk_fma_f32 v[100:101], v[100:101], v[108:109], v[110:111]
    v_pk_mul_f32 v[98:99], v[98:99], v[60:61]
    v_pk_mul_f32 v[100:101], v[100:101], v[62:63]
    v_exp_f32 v98, v98
    v_exp_f32 v100, v100
    v_exp_f32 v99, v99
    v_exp_f32 v101, v101
    v_pk_add_f32 v[98:99], v[98:99], v[112:113]
    v_pk_add_f32 v[100:101], v[100:101], v[112:113]
    v_rcp_f32 v98, v98
    v_rcp_f32 v100, v100
    v_rcp_f32 v99, v99
    v_rcp_f32 v101, v101
    v_pk_fma_f32 v[60:61], v[60:61], v[98:99], v[60:61] neg_lo:[1,0,0] neg_hi:[1,0,0]
    v_pk_fma_f32 v[62:63], v[62:63], v[100:101], v[62:63] neg_lo:[1,0,0] neg_hi:[1,0,0]
    v_cvt_pk_bf16_f32 v106, v60, v61
    v_cvt_pk_bf16_f32 v107, v62, v63
    buffer_store_dwordx2 v[106:107], v7, s[28:31], 0 offen offset:96
gemm1_kernel_done:
    s_endpgm
gemm1_kernel_helper:
    s_load_dwordx2 s[12:13], s[0:1], 72
    s_cmp_eq_u32 s31, 8
    s_cbranch_scc1 gemm1_kernel_hend
    s_sub_u32 s40, s2, 224
    s_lshl_b32 s40, s40, 3
    s_add_u32 s40, s40, s31
    s_mul_i32 s40, s40, 57344
    v_lshlrev_b32 v4, 4, v0
    v_add_u32 v4, s40, v4
    s_waitcnt lgkmcnt(0)

    s_mov_b32 s20, s12
    s_mov_b32 s21, s13
    s_and_b32 s21, s21, 0xffff
    s_mov_b32 s22, 0xe00000
    s_mov_b32 s23, 0x20000
    s_add_u32 s24, s4, 0x1500000
    s_addc_u32 s25, s5, 0
    s_and_b32 s25, s25, 0xffff
    s_mov_b32 s26, 0x1c0000
    s_mov_b32 s27, 0x20000
    s_sub_u32 s42, s2, 224
    s_lshl_b32 s42, s42, 3
    s_add_u32 s42, s42, s31
    s_lshr_b32 s43, s42, 6
    s_and_b32 s42, s42, 63
    s_mul_i32 s42, s42, 56
    v_lshrrev_b32 v5, 3, v0
    v_add_u32 v5, s42, v5
    v_and_b32 v6, 7, v0
    v_lshlrev_b32 v6, 4, v6
    s_lshl_b32 s44, s43, 10
    s_add_u32 s44, s44, 384
    v_lshl_add_u32 v7, v5, 12, v6
    v_add_u32 v7, s44, v7
    s_mul_i32 s44, s43, 458752
    v_lshl_add_u32 v9, v5, 7, v6
    v_add_u32 v9, s44, v9

    s_mov_b32 s41, 0
    buffer_load_dwordx4 v[16:19], v7, s[20:23], s41 offen
    s_mov_b32 s41, 32768
    buffer_load_dwordx4 v[20:23], v7, s[20:23], s41 offen
    s_mov_b32 s41, 65536
    buffer_load_dwordx4 v[24:27], v7, s[20:23], s41 offen
    s_mov_b32 s41, 98304
    buffer_load_dwordx4 v[28:31], v7, s[20:23], s41 offen
    s_mov_b32 s41, 131072
    buffer_load_dwordx4 v[32:35], v7, s[20:23], s41 offen
    s_mov_b32 s41, 163840
    buffer_load_dwordx4 v[36:39], v7, s[20:23], s41 offen
    s_mov_b32 s41, 196608
    buffer_load_dwordx4 v[40:43], v7, s[20:23], s41 offen
    s_waitcnt vmcnt(6)
    buffer_store_dwordx4 v[16:19], v9, s[24:27], 0 offen offset:0
    s_waitcnt vmcnt(6)
    buffer_store_dwordx4 v[20:23], v9, s[24:27], 0 offen offset:1024
    s_waitcnt vmcnt(6)
    buffer_store_dwordx4 v[24:27], v9, s[24:27], 0 offen offset:2048
    s_waitcnt vmcnt(6)
    buffer_store_dwordx4 v[28:31], v9, s[24:27], 0 offen offset:3072
    v_add_u32 v10, 4096, v9
    s_waitcnt vmcnt(6)
    buffer_store_dwordx4 v[32:35], v10, s[24:27], 0 offen offset:0
    s_waitcnt vmcnt(6)
    buffer_store_dwordx4 v[36:39], v10, s[24:27], 0 offen offset:1024
    s_waitcnt vmcnt(6)
    buffer_store_dwordx4 v[40:43], v10, s[24:27], 0 offen offset:2048
    s_barrier
    s_barrier
    s_barrier
    s_barrier
    s_barrier
    s_mov_b32 s41, 0
    buffer_load_dwordx4 v[48:51], v4, s[20:23], s41 offen
    s_mov_b32 s41, 1024
    buffer_load_dwordx4 v[48:51], v4, s[20:23], s41 offen
    s_mov_b32 s41, 2048
    buffer_load_dwordx4 v[48:51], v4, s[20:23], s41 offen
    s_mov_b32 s41, 3072
    buffer_load_dwordx4 v[48:51], v4, s[20:23], s41 offen
    s_mov_b32 s41, 4096
    buffer_load_dwordx4 v[48:51], v4, s[20:23], s41 offen
    s_mov_b32 s41, 5120
    buffer_load_dwordx4 v[48:51], v4, s[20:23], s41 offen
    s_mov_b32 s41, 6144
    buffer_load_dwordx4 v[48:51], v4, s[20:23], s41 offen
    s_mov_b32 s41, 7168
    buffer_load_dwordx4 v[48:51], v4, s[20:23], s41 offen
    s_mov_b32 s41, 8192
    buffer_load_dwordx4 v[48:51], v4, s[20:23], s41 offen
    s_mov_b32 s41, 9216
    buffer_load_dwordx4 v[48:51], v4, s[20:23], s41 offen
    s_mov_b32 s41, 10240
    buffer_load_dwordx4 v[48:51], v4, s[20:23], s41 offen
    s_mov_b32 s41, 11264
    buffer_load_dwordx4 v[48:51], v4, s[20:23], s41 offen
    s_mov_b32 s41, 12288
    buffer_load_dwordx4 v[48:51], v4, s[20:23], s41 offen
    s_mov_b32 s41, 13312
    buffer_load_dwordx4 v[48:51], v4, s[20:23], s41 offen
    s_mov_b32 s41, 14336
    buffer_load_dwordx4 v[48:51], v4, s[20:23], s41 offen
    s_mov_b32 s41, 15360
    buffer_load_dwordx4 v[48:51], v4, s[20:23], s41 offen
    s_mov_b32 s41, 16384
    buffer_load_dwordx4 v[48:51], v4, s[20:23], s41 offen
    s_mov_b32 s41, 17408
    buffer_load_dwordx4 v[48:51], v4, s[20:23], s41 offen
    s_mov_b32 s41, 18432
    buffer_load_dwordx4 v[48:51], v4, s[20:23], s41 offen
    s_mov_b32 s41, 19456
    buffer_load_dwordx4 v[48:51], v4, s[20:23], s41 offen
    s_mov_b32 s41, 20480
    buffer_load_dwordx4 v[48:51], v4, s[20:23], s41 offen
    s_mov_b32 s41, 21504
    buffer_load_dwordx4 v[48:51], v4, s[20:23], s41 offen
    s_mov_b32 s41, 22528
    buffer_load_dwordx4 v[48:51], v4, s[20:23], s41 offen
    s_mov_b32 s41, 23552
    buffer_load_dwordx4 v[48:51], v4, s[20:23], s41 offen
    s_mov_b32 s41, 24576
    buffer_load_dwordx4 v[48:51], v4, s[20:23], s41 offen
    s_mov_b32 s41, 25600
    buffer_load_dwordx4 v[48:51], v4, s[20:23], s41 offen
    s_mov_b32 s41, 26624
    buffer_load_dwordx4 v[48:51], v4, s[20:23], s41 offen
    s_mov_b32 s41, 27648
    buffer_load_dwordx4 v[48:51], v4, s[20:23], s41 offen
    s_mov_b32 s41, 28672
    buffer_load_dwordx4 v[48:51], v4, s[20:23], s41 offen
    s_mov_b32 s41, 29696
    buffer_load_dwordx4 v[48:51], v4, s[20:23], s41 offen
    s_mov_b32 s41, 30720
    buffer_load_dwordx4 v[48:51], v4, s[20:23], s41 offen
    s_mov_b32 s41, 31744
    buffer_load_dwordx4 v[48:51], v4, s[20:23], s41 offen
    s_mov_b32 s41, 32768
    buffer_load_dwordx4 v[48:51], v4, s[20:23], s41 offen
    s_mov_b32 s41, 33792
    buffer_load_dwordx4 v[48:51], v4, s[20:23], s41 offen
    s_mov_b32 s41, 34816
    buffer_load_dwordx4 v[48:51], v4, s[20:23], s41 offen
    s_mov_b32 s41, 35840
    buffer_load_dwordx4 v[48:51], v4, s[20:23], s41 offen
    s_mov_b32 s41, 36864
    buffer_load_dwordx4 v[48:51], v4, s[20:23], s41 offen
    s_mov_b32 s41, 37888
    buffer_load_dwordx4 v[48:51], v4, s[20:23], s41 offen
    s_mov_b32 s41, 38912
    buffer_load_dwordx4 v[48:51], v4, s[20:23], s41 offen
    s_mov_b32 s41, 39936
    buffer_load_dwordx4 v[48:51], v4, s[20:23], s41 offen
    s_mov_b32 s41, 40960
    buffer_load_dwordx4 v[48:51], v4, s[20:23], s41 offen
    s_mov_b32 s41, 41984
    buffer_load_dwordx4 v[48:51], v4, s[20:23], s41 offen
    s_mov_b32 s41, 43008
    buffer_load_dwordx4 v[48:51], v4, s[20:23], s41 offen
    s_mov_b32 s41, 44032
    buffer_load_dwordx4 v[48:51], v4, s[20:23], s41 offen
    s_mov_b32 s41, 45056
    buffer_load_dwordx4 v[48:51], v4, s[20:23], s41 offen
    s_mov_b32 s41, 46080
    buffer_load_dwordx4 v[48:51], v4, s[20:23], s41 offen
    s_mov_b32 s41, 47104
    buffer_load_dwordx4 v[48:51], v4, s[20:23], s41 offen
    s_mov_b32 s41, 48128
    buffer_load_dwordx4 v[48:51], v4, s[20:23], s41 offen
    s_mov_b32 s41, 49152
    buffer_load_dwordx4 v[48:51], v4, s[20:23], s41 offen
    s_mov_b32 s41, 50176
    buffer_load_dwordx4 v[48:51], v4, s[20:23], s41 offen
    s_mov_b32 s41, 51200
    buffer_load_dwordx4 v[48:51], v4, s[20:23], s41 offen
    s_mov_b32 s41, 52224
    buffer_load_dwordx4 v[48:51], v4, s[20:23], s41 offen
    s_mov_b32 s41, 53248
    buffer_load_dwordx4 v[48:51], v4, s[20:23], s41 offen
    s_mov_b32 s41, 54272
    buffer_load_dwordx4 v[48:51], v4, s[20:23], s41 offen
    s_mov_b32 s41, 55296
    buffer_load_dwordx4 v[48:51], v4, s[20:23], s41 offen
    s_mov_b32 s41, 56320
    buffer_load_dwordx4 v[48:51], v4, s[20:23], s41 offen
gemm1_kernel_hend:
    s_endpgm
gemm1_kernel_conv:
    s_load_dwordx4 s[12:15], s[0:1], 32
    s_sub_u32 s32, s31, 8
    s_lshl_b32 s33, s2, 2
    s_add_u32 s33, s33, s32
    s_lshl_b32 s34, s33, 12
    s_mul_i32 s35, s32, 13440
    s_add_u32 s35, s35, 98304
    s_lshr_b32 s36, s33, 1
    s_lshl_b32 s36, s36, 2
    v_subrev_u32 v2, 4, v0
    v_lshlrev_b32 v3, 4, v2
    v_add_u32 v4, 16, v3
    s_waitcnt lgkmcnt(0)
    s_add_u32 s14, s14, s36
    s_addc_u32 s15, s15, 0
    s_load_dword s37, s[14:15], 0

    s_add_u32 s16, s12, s34
    s_addc_u32 s17, s13, 0
    s_and_b32 s17, s17, 0xffff
    s_mov_b32 s18, 0x1000
    s_mov_b32 s19, 0x20000
    s_add_u32 s20, s4, s34
    s_addc_u32 s21, s5, 0
    s_add_u32 s20, s20, 0x400000
    s_addc_u32 s21, s21, 0
    s_and_b32 s21, s21, 0xffff
    s_mov_b32 s22, 0x1000
    s_mov_b32 s23, 0x20000
    s_add_u32 s24, s4, s34
    s_addc_u32 s25, s5, 0
    s_add_u32 s24, s24, 0x800000
    s_addc_u32 s25, s25, 0
    s_and_b32 s25, s25, 0xffff
    s_mov_b32 s26, 0x1000
    s_mov_b32 s27, 0x20000
    v_add_u32 v5, 0, v3
    v_add_u32 v6, 0, v4
    buffer_load_dwordx4 v[96:99], v5, s[16:19], 0 offen
    buffer_load_dwordx4 v[100:103], v6, s[16:19], 0 offen
    v_add_u32 v5, 1024, v3
    v_add_u32 v6, 1024, v4
    buffer_load_dwordx4 v[104:107], v5, s[16:19], 0 offen
    buffer_load_dwordx4 v[108:111], v6, s[16:19], 0 offen
    v_add_u32 v5, 2048, v3
    v_add_u32 v6, 2048, v4
    buffer_load_dwordx4 v[112:115], v5, s[16:19], 0 offen
    buffer_load_dwordx4 v[116:119], v6, s[16:19], 0 offen
    v_add_u32 v5, 3072, v3
    v_add_u32 v6, 3072, v4
    buffer_load_dwordx4 v[120:123], v5, s[16:19], 0 offen
    buffer_load_dwordx4 v[124:127], v6, s[16:19], 0 offen
    v_add_u32 v5, 4096, v3
    v_add_u32 v6, 4096, v4
    buffer_load_dwordx4 v[128:131], v5, s[16:19], 0 offen
    buffer_load_dwordx4 v[132:135], v6, s[16:19], 0 offen
    v_lshlrev_b32 v7, 4, v0
    buffer_load_dwordx4 v[140:143], v7, s[20:23], 0 offen offset:0
    buffer_load_dwordx4 v[144:147], v7, s[20:23], 0 offen offset:1024
    buffer_load_dwordx4 v[148:151], v7, s[20:23], 0 offen offset:2048
    buffer_load_dwordx4 v[152:155], v7, s[20:23], 0 offen offset:3072
    v_add_u32 v8, s35, v7
    v_mov_b32 v12, 0
    v_mov_b32 v13, 0
    v_mov_b32 v14, 0
    v_mov_b32 v15, 0
    v_lshrrev_b32 v9, 4, v0
    v_mul_u32_u24 v9, 1280, v9
    v_and_b32 v10, 15, v0
    v_lshlrev_b32 v10, 4, v10
    v_add3_u32 v9, v9, v10, s35
    ds_write_b128 v9, v[12:15] offset:8320
    v_mov_b32 v1, 0xffff0000

    s_barrier
    s_barrier
    s_barrier
    s_barrier
    s_waitcnt vmcnt(12)
    ds_write_b128 v8, v[96:99] offset:0
    v_alignbit_b32 v20, v97, v96, 16
    v_alignbit_b32 v21, v98, v97, 16
    v_alignbit_b32 v22, v99, v98, 16
    v_alignbit_b32 v23, v100, v99, 16
    ds_write_b128 v8, v[20:23] offset:4160
    s_waitcnt vmcnt(10)
    ds_write_b128 v8, v[104:107] offset:1024
    v_alignbit_b32 v24, v105, v104, 16
    v_alignbit_b32 v25, v106, v105, 16
    v_alignbit_b32 v26, v107, v106, 16
    v_alignbit_b32 v27, v108, v107, 16
    ds_write_b128 v8, v[24:27] offset:5184
    s_waitcnt vmcnt(8)
    ds_write_b128 v8, v[112:115] offset:2048
    v_alignbit_b32 v20, v113, v112, 16
    v_alignbit_b32 v21, v114, v113, 16
    v_alignbit_b32 v22, v115, v114, 16
    v_alignbit_b32 v23, v116, v115, 16
    ds_write_b128 v8, v[20:23] offset:6208
    s_waitcnt vmcnt(6)
    ds_write_b128 v8, v[120:123] offset:3072
    v_alignbit_b32 v24, v121, v120, 16
    v_alignbit_b32 v25, v122, v121, 16
    v_alignbit_b32 v26, v123, v122, 16
    v_alignbit_b32 v27, v124, v123, 16
    ds_write_b128 v8, v[24:27] offset:7232
    s_waitcnt vmcnt(4)
    v_cmp_gt_u32 vcc, 4, v0
    s_and_saveexec_b64 s[40:41], vcc
    ds_write_b128 v8, v[128:131] offset:4096
    v_alignbit_b32 v20, v129, v128, 16
    v_alignbit_b32 v21, v130, v129, 16
    v_alignbit_b32 v22, v131, v130, 16
    v_alignbit_b32 v23, v132, v131, 16
    ds_write_b128 v8, v[20:23] offset:8256
    s_mov_b64 exec, s[40:41]
    s_waitcnt vmcnt(0)
    v_and_b32 v9, 3, v0
    v_mul_u32_u24 v9, 1280, v9
    v_lshrrev_b32 v10, 2, v0
    v_lshl_add_u32 v9, v10, 4, v9
    v_add_u32 v9, s35, v9

    ds_write_b128 v9, v[140:143] offset:8576
    ds_write_b128 v9, v[144:147] offset:8832
    ds_write_b128 v9, v[148:151] offset:9088
    ds_write_b128 v9, v[152:155] offset:9344
    v_and_b32 v5, 15, v0
    v_lshrrev_b32 v4, 4, v0
    v_add_u32 v2, 1, v5
    v_and_b32 v2, 1, v2
    v_lshlrev_b32 v3, 3, v4
    v_sub_u32 v3, v5, v3
    v_add_u32 v3, 25, v3
    v_sub_u32 v3, v3, v2
    v_lshlrev_b32 v3, 1, v3
    v_mul_u32_u24 v2, 4160, v2
    v_add3_u32 v2, v2, v3, s35
    v_mul_u32_u24 v3, 1280, v4
    v_add_u32 v6, 1, v5
    v_lshlrev_b32 v6, 4, v6
    v_add3_u32 v3, v3, v6, s35

    v_mov_b32 v64, 0
    v_mov_b32 v65, 0
    v_mov_b32 v66, 0
    v_mov_b32 v67, 0
    v_mov_b32 v68, 0
    v_mov_b32 v69, 0
    v_mov_b32 v70, 0
    v_mov_b32 v71, 0
    v_mov_b32 v72, 0
    v_mov_b32 v73, 0
    v_mov_b32 v74, 0
    v_mov_b32 v75, 0
    v_mov_b32 v76, 0
    v_mov_b32 v77, 0
    v_mov_b32 v78, 0
    v_mov_b32 v79, 0
    v_mov_b32 v80, 0
    v_mov_b32 v81, 0
    v_mov_b32 v82, 0
    v_mov_b32 v83, 0
    v_mov_b32 v84, 0
    v_mov_b32 v85, 0
    v_mov_b32 v86, 0
    v_mov_b32 v87, 0
    v_mov_b32 v88, 0
    v_mov_b32 v89, 0
    v_mov_b32 v90, 0
    v_mov_b32 v91, 0
    v_mov_b32 v92, 0
    v_mov_b32 v93, 0
    v_mov_b32 v94, 0
    v_mov_b32 v95, 0
    s_waitcnt lgkmcnt(0)
    s_barrier
    ds_read2_b32 v[96:97], v2 offset0:0 offset1:1
    ds_read2_b32 v[98:99], v2 offset0:2 offset1:3
    ds_read2_b32 v[100:101], v2 offset0:8 offset1:9
    ds_read2_b32 v[102:103], v2 offset0:10 offset1:11
    ds_read_b128 v[104:107], v3 offset:8560
    ds_read_b128 v[108:111], v3 offset:8816
    ds_read_b128 v[112:115], v3 offset:9072
    ds_read_b128 v[116:119], v3 offset:9328
    ds_read2_b32 v[120:121], v2 offset0:16 offset1:17
    ds_read2_b32 v[122:123], v2 offset0:18 offset1:19
    ds_read2_b32 v[124:125], v2 offset0:24 offset1:25
    ds_read2_b32 v[126:127], v2 offset0:26 offset1:27
    ds_read_b128 v[128:131], v3 offset:8544
    ds_read_b128 v[132:135], v3 offset:8800
    ds_read_b128 v[136:139], v3 offset:9056
    ds_read_b128 v[140:143], v3 offset:9312
    s_waitcnt lgkmcnt(8)
    v_mfma_f32_16x16x32_bf16 v[64:67], v[96:99], v[104:107], v[64:67]
    v_mfma_f32_16x16x32_bf16 v[80:83], v[100:103], v[104:107], v[80:83]
    v_mfma_f32_16x16x32_bf16 v[68:71], v[96:99], v[108:111], v[68:71]
    v_mfma_f32_16x16x32_bf16 v[84:87], v[100:103], v[108:111], v[84:87]
    v_mfma_f32_16x16x32_bf16 v[72:75], v[96:99], v[112:115], v[72:75]
    v_mfma_f32_16x16x32_bf16 v[88:91], v[100:103], v[112:115], v[88:91]
    v_mfma_f32_16x16x32_bf16 v[76:79], v[96:99], v[116:119], v[76:79]
    v_mfma_f32_16x16x32_bf16 v[92:95], v[100:103], v[116:119], v[92:95]
    ds_read2_b32 v[96:97], v2 offset0:32 offset1:33
    ds_read2_b32 v[98:99], v2 offset0:34 offset1:35
    ds_read2_b32 v[100:101], v2 offset0:40 offset1:41
    ds_read2_b32 v[102:103], v2 offset0:42 offset1:43
    ds_read_b128 v[104:107], v3 offset:8528
    ds_read_b128 v[108:111], v3 offset:8784
    ds_read_b128 v[112:115], v3 offset:9040
    ds_read_b128 v[116:119], v3 offset:9296
    s_waitcnt lgkmcnt(8)
    v_mfma_f32_16x16x32_bf16 v[64:67], v[120:123], v[128:131], v[64:67]
    v_mfma_f32_16x16x32_bf16 v[80:83], v[124:127], v[128:131], v[80:83]
    v_mfma_f32_16x16x32_bf16 v[68:71], v[120:123], v[132:135], v[68:71]
    v_mfma_f32_16x16x32_bf16 v[84:87], v[124:127], v[132:135], v[84:87]
    s_barrier
    v_mfma_f32_16x16x32_bf16 v[72:75], v[120:123], v[136:139], v[72:75]
    v_mfma_f32_16x16x32_bf16 v[88:91], v[124:127], v[136:139], v[88:91]
    v_mfma_f32_16x16x32_bf16 v[76:79], v[120:123], v[140:143], v[76:79]
    v_mfma_f32_16x16x32_bf16 v[92:95], v[124:127], v[140:143], v[92:95]
    ds_read2_b32 v[120:121], v2 offset0:48 offset1:49
    ds_read2_b32 v[122:123], v2 offset0:50 offset1:51
    ds_read2_b32 v[124:125], v2 offset0:56 offset1:57
    ds_read2_b32 v[126:127], v2 offset0:58 offset1:59
    ds_read_b128 v[128:131], v3 offset:8512
    ds_read_b128 v[132:135], v3 offset:8768
    ds_read_b128 v[136:139], v3 offset:9024
    ds_read_b128 v[140:143], v3 offset:9280
    s_waitcnt lgkmcnt(8)
    v_mfma_f32_16x16x32_bf16 v[64:67], v[96:99], v[104:107], v[64:67]
    v_mfma_f32_16x16x32_bf16 v[80:83], v[100:103], v[104:107], v[80:83]
    v_mfma_f32_16x16x32_bf16 v[68:71], v[96:99], v[108:111], v[68:71]
    v_mfma_f32_16x16x32_bf16 v[84:87], v[100:103], v[108:111], v[84:87]
    v_mfma_f32_16x16x32_bf16 v[72:75], v[96:99], v[112:115], v[72:75]
    v_mfma_f32_16x16x32_bf16 v[88:91], v[100:103], v[112:115], v[88:91]
    v_mfma_f32_16x16x32_bf16 v[76:79], v[96:99], v[116:119], v[76:79]
    v_mfma_f32_16x16x32_bf16 v[92:95], v[100:103], v[116:119], v[92:95]
    s_barrier
    ds_read2_b32 v[96:97], v2 offset0:64 offset1:65
    ds_read2_b32 v[98:99], v2 offset0:66 offset1:67
    ds_read2_b32 v[100:101], v2 offset0:72 offset1:73
    ds_read2_b32 v[102:103], v2 offset0:74 offset1:75
    ds_read_b128 v[104:107], v3 offset:8496
    ds_read_b128 v[108:111], v3 offset:8752
    ds_read_b128 v[112:115], v3 offset:9008
    ds_read_b128 v[116:119], v3 offset:9264
    s_waitcnt lgkmcnt(8)
    v_mfma_f32_16x16x32_bf16 v[64:67], v[120:123], v[128:131], v[64:67]
    v_mfma_f32_16x16x32_bf16 v[80:83], v[124:127], v[128:131], v[80:83]
    v_mfma_f32_16x16x32_bf16 v[68:71], v[120:123], v[132:135], v[68:71]
    v_mfma_f32_16x16x32_bf16 v[84:87], v[124:127], v[132:135], v[84:87]
    v_mfma_f32_16x16x32_bf16 v[72:75], v[120:123], v[136:139], v[72:75]
    v_mfma_f32_16x16x32_bf16 v[88:91], v[124:127], v[136:139], v[88:91]
    v_mfma_f32_16x16x32_bf16 v[76:79], v[120:123], v[140:143], v[76:79]
    v_mfma_f32_16x16x32_bf16 v[92:95], v[124:127], v[140:143], v[92:95]
    ds_read2_b32 v[120:121], v2 offset0:80 offset1:81
    ds_read2_b32 v[122:123], v2 offset0:82 offset1:83
    ds_read2_b32 v[124:125], v2 offset0:88 offset1:89
    ds_read2_b32 v[126:127], v2 offset0:90 offset1:91
    ds_read_b128 v[128:131], v3 offset:8480
    ds_read_b128 v[132:135], v3 offset:8736
    ds_read_b128 v[136:139], v3 offset:8992
    ds_read_b128 v[140:143], v3 offset:9248
    s_waitcnt lgkmcnt(8)
    v_mfma_f32_16x16x32_bf16 v[64:67], v[96:99], v[104:107], v[64:67]
    v_mfma_f32_16x16x32_bf16 v[80:83], v[100:103], v[104:107], v[80:83]
    v_mfma_f32_16x16x32_bf16 v[68:71], v[96:99], v[108:111], v[68:71]
    v_mfma_f32_16x16x32_bf16 v[84:87], v[100:103], v[108:111], v[84:87]
    s_barrier
    v_mfma_f32_16x16x32_bf16 v[72:75], v[96:99], v[112:115], v[72:75]
    v_mfma_f32_16x16x32_bf16 v[88:91], v[100:103], v[112:115], v[88:91]
    v_mfma_f32_16x16x32_bf16 v[76:79], v[96:99], v[116:119], v[76:79]
    v_mfma_f32_16x16x32_bf16 v[92:95], v[100:103], v[116:119], v[92:95]
    ds_read2_b32 v[96:97], v2 offset0:96 offset1:97
    ds_read2_b32 v[98:99], v2 offset0:98 offset1:99
    ds_read2_b32 v[100:101], v2 offset0:104 offset1:105
    ds_read2_b32 v[102:103], v2 offset0:106 offset1:107
    ds_read_b128 v[104:107], v3 offset:8464
    ds_read_b128 v[108:111], v3 offset:8720
    ds_read_b128 v[112:115], v3 offset:8976
    ds_read_b128 v[116:119], v3 offset:9232
    s_waitcnt lgkmcnt(8)
    v_mfma_f32_16x16x32_bf16 v[64:67], v[120:123], v[128:131], v[64:67]
    v_mfma_f32_16x16x32_bf16 v[80:83], v[124:127], v[128:131], v[80:83]
    v_mfma_f32_16x16x32_bf16 v[68:71], v[120:123], v[132:135], v[68:71]
    v_mfma_f32_16x16x32_bf16 v[84:87], v[124:127], v[132:135], v[84:87]
    v_mfma_f32_16x16x32_bf16 v[72:75], v[120:123], v[136:139], v[72:75]
    v_mfma_f32_16x16x32_bf16 v[88:91], v[124:127], v[136:139], v[88:91]
    v_mfma_f32_16x16x32_bf16 v[76:79], v[120:123], v[140:143], v[76:79]
    v_mfma_f32_16x16x32_bf16 v[92:95], v[124:127], v[140:143], v[92:95]
    s_barrier
    ds_read2_b32 v[120:121], v2 offset0:112 offset1:113
    ds_read2_b32 v[122:123], v2 offset0:114 offset1:115
    ds_read2_b32 v[124:125], v2 offset0:120 offset1:121
    ds_read2_b32 v[126:127], v2 offset0:122 offset1:123
    ds_read_b128 v[128:131], v3 offset:8448
    ds_read_b128 v[132:135], v3 offset:8704
    ds_read_b128 v[136:139], v3 offset:8960
    ds_read_b128 v[140:143], v3 offset:9216
    s_waitcnt lgkmcnt(8)
    v_mfma_f32_16x16x32_bf16 v[64:67], v[96:99], v[104:107], v[64:67]
    v_mfma_f32_16x16x32_bf16 v[80:83], v[100:103], v[104:107], v[80:83]
    v_mfma_f32_16x16x32_bf16 v[68:71], v[96:99], v[108:111], v[68:71]
    v_mfma_f32_16x16x32_bf16 v[84:87], v[100:103], v[108:111], v[84:87]
    v_mfma_f32_16x16x32_bf16 v[72:75], v[96:99], v[112:115], v[72:75]
    v_mfma_f32_16x16x32_bf16 v[88:91], v[100:103], v[112:115], v[88:91]
    v_mfma_f32_16x16x32_bf16 v[76:79], v[96:99], v[116:119], v[76:79]
    v_mfma_f32_16x16x32_bf16 v[92:95], v[100:103], v[116:119], v[92:95]
    v_add_u32 v2, 512, v2
    ds_read2_b32 v[96:97], v2 offset0:0 offset1:1
    ds_read2_b32 v[98:99], v2 offset0:2 offset1:3
    ds_read2_b32 v[100:101], v2 offset0:8 offset1:9
    ds_read2_b32 v[102:103], v2 offset0:10 offset1:11
    ds_read_b128 v[104:107], v3 offset:8432
    ds_read_b128 v[108:111], v3 offset:8688
    ds_read_b128 v[112:115], v3 offset:8944
    ds_read_b128 v[116:119], v3 offset:9200
    s_waitcnt lgkmcnt(8)
    v_mfma_f32_16x16x32_bf16 v[64:67], v[120:123], v[128:131], v[64:67]
    v_mfma_f32_16x16x32_bf16 v[80:83], v[124:127], v[128:131], v[80:83]
    v_mfma_f32_16x16x32_bf16 v[68:71], v[120:123], v[132:135], v[68:71]
    v_mfma_f32_16x16x32_bf16 v[84:87], v[124:127], v[132:135], v[84:87]
    s_barrier
    v_mfma_f32_16x16x32_bf16 v[72:75], v[120:123], v[136:139], v[72:75]
    v_mfma_f32_16x16x32_bf16 v[88:91], v[124:127], v[136:139], v[88:91]
    v_mfma_f32_16x16x32_bf16 v[76:79], v[120:123], v[140:143], v[76:79]
    v_mfma_f32_16x16x32_bf16 v[92:95], v[124:127], v[140:143], v[92:95]
    ds_read2_b32 v[120:121], v2 offset0:16 offset1:17
    ds_read2_b32 v[122:123], v2 offset0:18 offset1:19
    ds_read2_b32 v[124:125], v2 offset0:24 offset1:25
    ds_read2_b32 v[126:127], v2 offset0:26 offset1:27
    ds_read_b128 v[128:131], v3 offset:8416
    ds_read_b128 v[132:135], v3 offset:8672
    ds_read_b128 v[136:139], v3 offset:8928
    ds_read_b128 v[140:143], v3 offset:9184
    s_waitcnt lgkmcnt(8)
    v_mfma_f32_16x16x32_bf16 v[64:67], v[96:99], v[104:107], v[64:67]
    v_mfma_f32_16x16x32_bf16 v[80:83], v[100:103], v[104:107], v[80:83]
    v_mfma_f32_16x16x32_bf16 v[68:71], v[96:99], v[108:111], v[68:71]
    v_mfma_f32_16x16x32_bf16 v[84:87], v[100:103], v[108:111], v[84:87]
    v_mfma_f32_16x16x32_bf16 v[72:75], v[96:99], v[112:115], v[72:75]
    v_mfma_f32_16x16x32_bf16 v[88:91], v[100:103], v[112:115], v[88:91]
    v_mfma_f32_16x16x32_bf16 v[76:79], v[96:99], v[116:119], v[76:79]
    v_mfma_f32_16x16x32_bf16 v[92:95], v[100:103], v[116:119], v[92:95]
    s_barrier
    ds_read2_b32 v[96:97], v2 offset0:32 offset1:33
    ds_read2_b32 v[98:99], v2 offset0:34 offset1:35
    ds_read2_b32 v[100:101], v2 offset0:40 offset1:41
    ds_read2_b32 v[102:103], v2 offset0:42 offset1:43
    ds_read_b128 v[104:107], v3 offset:8400
    ds_read_b128 v[108:111], v3 offset:8656
    ds_read_b128 v[112:115], v3 offset:8912
    ds_read_b128 v[116:119], v3 offset:9168
    s_waitcnt lgkmcnt(8)
    v_mfma_f32_16x16x32_bf16 v[64:67], v[120:123], v[128:131], v[64:67]
    v_mfma_f32_16x16x32_bf16 v[80:83], v[124:127], v[128:131], v[80:83]
    v_mfma_f32_16x16x32_bf16 v[68:71], v[120:123], v[132:135], v[68:71]
    v_mfma_f32_16x16x32_bf16 v[84:87], v[124:127], v[132:135], v[84:87]
    v_mfma_f32_16x16x32_bf16 v[72:75], v[120:123], v[136:139], v[72:75]
    v_mfma_f32_16x16x32_bf16 v[88:91], v[124:127], v[136:139], v[88:91]
    v_mfma_f32_16x16x32_bf16 v[76:79], v[120:123], v[140:143], v[76:79]
    v_mfma_f32_16x16x32_bf16 v[92:95], v[124:127], v[140:143], v[92:95]
    ds_read2_b32 v[120:121], v2 offset0:48 offset1:49
    ds_read2_b32 v[122:123], v2 offset0:50 offset1:51
    ds_read2_b32 v[124:125], v2 offset0:56 offset1:57
    ds_read2_b32 v[126:127], v2 offset0:58 offset1:59
    ds_read_b128 v[128:131], v3 offset:8384
    ds_read_b128 v[132:135], v3 offset:8640
    ds_read_b128 v[136:139], v3 offset:8896
    ds_read_b128 v[140:143], v3 offset:9152
    s_waitcnt lgkmcnt(8)
    v_mfma_f32_16x16x32_bf16 v[64:67], v[96:99], v[104:107], v[64:67]
    v_mfma_f32_16x16x32_bf16 v[80:83], v[100:103], v[104:107], v[80:83]
    v_mfma_f32_16x16x32_bf16 v[68:71], v[96:99], v[108:111], v[68:71]
    v_mfma_f32_16x16x32_bf16 v[84:87], v[100:103], v[108:111], v[84:87]
    s_barrier
    v_mfma_f32_16x16x32_bf16 v[72:75], v[96:99], v[112:115], v[72:75]
    v_mfma_f32_16x16x32_bf16 v[88:91], v[100:103], v[112:115], v[88:91]
    v_mfma_f32_16x16x32_bf16 v[76:79], v[96:99], v[116:119], v[76:79]
    v_mfma_f32_16x16x32_bf16 v[92:95], v[100:103], v[116:119], v[92:95]
    ds_read2_b32 v[96:97], v2 offset0:64 offset1:65
    ds_read2_b32 v[98:99], v2 offset0:66 offset1:67
    ds_read2_b32 v[100:101], v2 offset0:72 offset1:73
    ds_read2_b32 v[102:103], v2 offset0:74 offset1:75
    ds_read_b128 v[104:107], v3 offset:8368
    ds_read_b128 v[108:111], v3 offset:8624
    ds_read_b128 v[112:115], v3 offset:8880
    ds_read_b128 v[116:119], v3 offset:9136
    s_waitcnt lgkmcnt(8)
    v_mfma_f32_16x16x32_bf16 v[64:67], v[120:123], v[128:131], v[64:67]
    v_mfma_f32_16x16x32_bf16 v[80:83], v[124:127], v[128:131], v[80:83]
    v_mfma_f32_16x16x32_bf16 v[68:71], v[120:123], v[132:135], v[68:71]
    v_mfma_f32_16x16x32_bf16 v[84:87], v[124:127], v[132:135], v[84:87]
    v_mfma_f32_16x16x32_bf16 v[72:75], v[120:123], v[136:139], v[72:75]
    v_mfma_f32_16x16x32_bf16 v[88:91], v[124:127], v[136:139], v[88:91]
    v_mfma_f32_16x16x32_bf16 v[76:79], v[120:123], v[140:143], v[76:79]
    v_mfma_f32_16x16x32_bf16 v[92:95], v[124:127], v[140:143], v[92:95]
    s_barrier
    ds_read2_b32 v[120:121], v2 offset0:80 offset1:81
    ds_read2_b32 v[122:123], v2 offset0:82 offset1:83
    ds_read2_b32 v[124:125], v2 offset0:88 offset1:89
    ds_read2_b32 v[126:127], v2 offset0:90 offset1:91
    ds_read_b128 v[128:131], v3 offset:8352
    ds_read_b128 v[132:135], v3 offset:8608
    ds_read_b128 v[136:139], v3 offset:8864
    ds_read_b128 v[140:143], v3 offset:9120
    s_waitcnt lgkmcnt(8)
    v_mfma_f32_16x16x32_bf16 v[64:67], v[96:99], v[104:107], v[64:67]
    v_mfma_f32_16x16x32_bf16 v[80:83], v[100:103], v[104:107], v[80:83]
    v_mfma_f32_16x16x32_bf16 v[68:71], v[96:99], v[108:111], v[68:71]
    v_mfma_f32_16x16x32_bf16 v[84:87], v[100:103], v[108:111], v[84:87]
    v_mfma_f32_16x16x32_bf16 v[72:75], v[96:99], v[112:115], v[72:75]
    v_mfma_f32_16x16x32_bf16 v[88:91], v[100:103], v[112:115], v[88:91]
    v_mfma_f32_16x16x32_bf16 v[76:79], v[96:99], v[116:119], v[76:79]
    v_mfma_f32_16x16x32_bf16 v[92:95], v[100:103], v[116:119], v[92:95]
    ds_read2_b32 v[96:97], v2 offset0:96 offset1:97
    ds_read2_b32 v[98:99], v2 offset0:98 offset1:99
    ds_read2_b32 v[100:101], v2 offset0:104 offset1:105
    ds_read2_b32 v[102:103], v2 offset0:106 offset1:107
    ds_read_b128 v[104:107], v3 offset:8336
    ds_read_b128 v[108:111], v3 offset:8592
    ds_read_b128 v[112:115], v3 offset:8848
    ds_read_b128 v[116:119], v3 offset:9104
    s_waitcnt lgkmcnt(8)
    v_mfma_f32_16x16x32_bf16 v[64:67], v[120:123], v[128:131], v[64:67]
    v_mfma_f32_16x16x32_bf16 v[80:83], v[124:127], v[128:131], v[80:83]
    v_mfma_f32_16x16x32_bf16 v[68:71], v[120:123], v[132:135], v[68:71]
    v_mfma_f32_16x16x32_bf16 v[84:87], v[124:127], v[132:135], v[84:87]
    s_barrier
    v_mfma_f32_16x16x32_bf16 v[72:75], v[120:123], v[136:139], v[72:75]
    v_mfma_f32_16x16x32_bf16 v[88:91], v[124:127], v[136:139], v[88:91]
    v_mfma_f32_16x16x32_bf16 v[76:79], v[120:123], v[140:143], v[76:79]
    v_mfma_f32_16x16x32_bf16 v[92:95], v[124:127], v[140:143], v[92:95]
    ds_read2_b32 v[120:121], v2 offset0:112 offset1:113
    ds_read2_b32 v[122:123], v2 offset0:114 offset1:115
    ds_read2_b32 v[124:125], v2 offset0:120 offset1:121
    ds_read2_b32 v[126:127], v2 offset0:122 offset1:123
    ds_read_b128 v[128:131], v3 offset:8320
    ds_read_b128 v[132:135], v3 offset:8576
    ds_read_b128 v[136:139], v3 offset:8832
    ds_read_b128 v[140:143], v3 offset:9088
    s_waitcnt lgkmcnt(8)
    v_mfma_f32_16x16x32_bf16 v[64:67], v[96:99], v[104:107], v[64:67]
    v_mfma_f32_16x16x32_bf16 v[80:83], v[100:103], v[104:107], v[80:83]
    v_mfma_f32_16x16x32_bf16 v[68:71], v[96:99], v[108:111], v[68:71]
    v_mfma_f32_16x16x32_bf16 v[84:87], v[100:103], v[108:111], v[84:87]
    v_mfma_f32_16x16x32_bf16 v[72:75], v[96:99], v[112:115], v[72:75]
    v_mfma_f32_16x16x32_bf16 v[88:91], v[100:103], v[112:115], v[88:91]
    v_mfma_f32_16x16x32_bf16 v[76:79], v[96:99], v[116:119], v[76:79]
    v_mfma_f32_16x16x32_bf16 v[92:95], v[100:103], v[116:119], v[92:95]
    s_barrier
    v_add_u32 v2, 512, v2
    ds_read2_b32 v[96:97], v2 offset0:0 offset1:1
    ds_read2_b32 v[98:99], v2 offset0:2 offset1:3
    ds_read2_b32 v[100:101], v2 offset0:8 offset1:9
    ds_read2_b32 v[102:103], v2 offset0:10 offset1:11
    ds_read_b128 v[108:111], v3 offset:8560
    ds_read_b128 v[112:115], v3 offset:8816
    ds_read_b128 v[116:119], v3 offset:9072
    s_waitcnt lgkmcnt(7)
    v_mfma_f32_16x16x32_bf16 v[64:67], v[120:123], v[128:131], v[64:67]
    v_mfma_f32_16x16x32_bf16 v[80:83], v[124:127], v[128:131], v[80:83]
    v_mfma_f32_16x16x32_bf16 v[68:71], v[120:123], v[132:135], v[68:71]
    v_mfma_f32_16x16x32_bf16 v[84:87], v[124:127], v[132:135], v[84:87]
    v_mfma_f32_16x16x32_bf16 v[72:75], v[120:123], v[136:139], v[72:75]
    v_mfma_f32_16x16x32_bf16 v[88:91], v[124:127], v[136:139], v[88:91]
    v_mfma_f32_16x16x32_bf16 v[76:79], v[120:123], v[140:143], v[76:79]
    v_mfma_f32_16x16x32_bf16 v[92:95], v[124:127], v[140:143], v[92:95]
    ds_read2_b32 v[120:121], v2 offset0:16 offset1:17
    ds_read2_b32 v[122:123], v2 offset0:18 offset1:19
    ds_read2_b32 v[124:125], v2 offset0:24 offset1:25
    ds_read2_b32 v[126:127], v2 offset0:26 offset1:27
    ds_read_b128 v[132:135], v3 offset:8544
    ds_read_b128 v[136:139], v3 offset:8800
    ds_read_b128 v[140:143], v3 offset:9056
    s_waitcnt lgkmcnt(7)
    v_mfma_f32_16x16x32_bf16 v[68:71], v[96:99], v[108:111], v[68:71]
    v_mfma_f32_16x16x32_bf16 v[84:87], v[100:103], v[108:111], v[84:87]
    v_mfma_f32_16x16x32_bf16 v[72:75], v[96:99], v[112:115], v[72:75]
    v_mfma_f32_16x16x32_bf16 v[88:91], v[100:103], v[112:115], v[88:91]
    s_barrier
    v_mfma_f32_16x16x32_bf16 v[76:79], v[96:99], v[116:119], v[76:79]
    v_mfma_f32_16x16x32_bf16 v[92:95], v[100:103], v[116:119], v[92:95]
    ds_read2_b32 v[96:97], v2 offset0:32 offset1:33
    ds_read2_b32 v[98:99], v2 offset0:34 offset1:35
    ds_read2_b32 v[100:101], v2 offset0:40 offset1:41
    ds_read2_b32 v[102:103], v2 offset0:42 offset1:43
    ds_read_b128 v[108:111], v3 offset:8528
    ds_read_b128 v[112:115], v3 offset:8784
    ds_read_b128 v[116:119], v3 offset:9040
    s_waitcnt lgkmcnt(7)
    v_mfma_f32_16x16x32_bf16 v[68:71], v[120:123], v[132:135], v[68:71]
    v_mfma_f32_16x16x32_bf16 v[84:87], v[124:127], v[132:135], v[84:87]
    v_mfma_f32_16x16x32_bf16 v[72:75], v[120:123], v[136:139], v[72:75]
    v_mfma_f32_16x16x32_bf16 v[88:91], v[124:127], v[136:139], v[88:91]
    v_mfma_f32_16x16x32_bf16 v[76:79], v[120:123], v[140:143], v[76:79]
    v_mfma_f32_16x16x32_bf16 v[92:95], v[124:127], v[140:143], v[92:95]
    ds_read2_b32 v[120:121], v2 offset0:48 offset1:49
    ds_read2_b32 v[122:123], v2 offset0:50 offset1:51
    ds_read2_b32 v[124:125], v2 offset0:56 offset1:57
    ds_read2_b32 v[126:127], v2 offset0:58 offset1:59
    ds_read_b128 v[132:135], v3 offset:8512
    ds_read_b128 v[136:139], v3 offset:8768
    ds_read_b128 v[140:143], v3 offset:9024
    s_waitcnt lgkmcnt(7)
    v_mfma_f32_16x16x32_bf16 v[68:71], v[96:99], v[108:111], v[68:71]
    v_mfma_f32_16x16x32_bf16 v[84:87], v[100:103], v[108:111], v[84:87]
    v_mfma_f32_16x16x32_bf16 v[72:75], v[96:99], v[112:115], v[72:75]
    v_mfma_f32_16x16x32_bf16 v[88:91], v[100:103], v[112:115], v[88:91]
    s_barrier
    v_mfma_f32_16x16x32_bf16 v[76:79], v[96:99], v[116:119], v[76:79]
    v_mfma_f32_16x16x32_bf16 v[92:95], v[100:103], v[116:119], v[92:95]
    ds_read2_b32 v[96:97], v2 offset0:64 offset1:65
    ds_read2_b32 v[98:99], v2 offset0:66 offset1:67
    ds_read2_b32 v[100:101], v2 offset0:72 offset1:73
    ds_read2_b32 v[102:103], v2 offset0:74 offset1:75
    ds_read_b128 v[108:111], v3 offset:8496
    ds_read_b128 v[112:115], v3 offset:8752
    ds_read_b128 v[116:119], v3 offset:9008
    s_waitcnt lgkmcnt(7)
    v_mfma_f32_16x16x32_bf16 v[68:71], v[120:123], v[132:135], v[68:71]
    v_mfma_f32_16x16x32_bf16 v[84:87], v[124:127], v[132:135], v[84:87]
    v_mfma_f32_16x16x32_bf16 v[72:75], v[120:123], v[136:139], v[72:75]
    v_mfma_f32_16x16x32_bf16 v[88:91], v[124:127], v[136:139], v[88:91]
    v_mfma_f32_16x16x32_bf16 v[76:79], v[120:123], v[140:143], v[76:79]
    v_mfma_f32_16x16x32_bf16 v[92:95], v[124:127], v[140:143], v[92:95]
    ds_read2_b32 v[120:121], v2 offset0:80 offset1:81
    ds_read2_b32 v[122:123], v2 offset0:82 offset1:83
    ds_read2_b32 v[124:125], v2 offset0:88 offset1:89
    ds_read2_b32 v[126:127], v2 offset0:90 offset1:91
    ds_read_b128 v[132:135], v3 offset:8480
    ds_read_b128 v[136:139], v3 offset:8736
    ds_read_b128 v[140:143], v3 offset:8992
    s_waitcnt lgkmcnt(7)
    v_mfma_f32_16x16x32_bf16 v[68:71], v[96:99], v[108:111], v[68:71]
    v_mfma_f32_16x16x32_bf16 v[84:87], v[100:103], v[108:111], v[84:87]
    v_mfma_f32_16x16x32_bf16 v[72:75], v[96:99], v[112:115], v[72:75]
    v_mfma_f32_16x16x32_bf16 v[88:91], v[100:103], v[112:115], v[88:91]
    s_barrier
    v_mfma_f32_16x16x32_bf16 v[76:79], v[96:99], v[116:119], v[76:79]
    v_mfma_f32_16x16x32_bf16 v[92:95], v[100:103], v[116:119], v[92:95]
    ds_read2_b32 v[96:97], v2 offset0:96 offset1:97
    ds_read2_b32 v[98:99], v2 offset0:98 offset1:99
    ds_read2_b32 v[100:101], v2 offset0:104 offset1:105
    ds_read2_b32 v[102:103], v2 offset0:106 offset1:107
    ds_read_b128 v[108:111], v3 offset:8464
    ds_read_b128 v[112:115], v3 offset:8720
    ds_read_b128 v[116:119], v3 offset:8976
    s_waitcnt lgkmcnt(7)
    v_mfma_f32_16x16x32_bf16 v[68:71], v[120:123], v[132:135], v[68:71]
    v_mfma_f32_16x16x32_bf16 v[84:87], v[124:127], v[132:135], v[84:87]
    v_mfma_f32_16x16x32_bf16 v[72:75], v[120:123], v[136:139], v[72:75]
    v_mfma_f32_16x16x32_bf16 v[88:91], v[124:127], v[136:139], v[88:91]
    v_mfma_f32_16x16x32_bf16 v[76:79], v[120:123], v[140:143], v[76:79]
    v_mfma_f32_16x16x32_bf16 v[92:95], v[124:127], v[140:143], v[92:95]
    ds_read2_b32 v[120:121], v2 offset0:112 offset1:113
    ds_read2_b32 v[122:123], v2 offset0:114 offset1:115
    ds_read2_b32 v[124:125], v2 offset0:120 offset1:121
    ds_read2_b32 v[126:127], v2 offset0:122 offset1:123
    ds_read_b128 v[132:135], v3 offset:8448
    ds_read_b128 v[136:139], v3 offset:8704
    ds_read_b128 v[140:143], v3 offset:8960
    s_waitcnt lgkmcnt(7)
    v_mfma_f32_16x16x32_bf16 v[68:71], v[96:99], v[108:111], v[68:71]
    v_mfma_f32_16x16x32_bf16 v[84:87], v[100:103], v[108:111], v[84:87]
    v_mfma_f32_16x16x32_bf16 v[72:75], v[96:99], v[112:115], v[72:75]
    v_mfma_f32_16x16x32_bf16 v[88:91], v[100:103], v[112:115], v[88:91]
    s_barrier
    v_mfma_f32_16x16x32_bf16 v[76:79], v[96:99], v[116:119], v[76:79]
    v_mfma_f32_16x16x32_bf16 v[92:95], v[100:103], v[116:119], v[92:95]
    v_add_u32 v2, 512, v2
    ds_read2_b32 v[96:97], v2 offset0:0 offset1:1
    ds_read2_b32 v[98:99], v2 offset0:2 offset1:3
    ds_read2_b32 v[100:101], v2 offset0:8 offset1:9
    ds_read2_b32 v[102:103], v2 offset0:10 offset1:11
    ds_read_b128 v[108:111], v3 offset:8432
    ds_read_b128 v[112:115], v3 offset:8688
    ds_read_b128 v[116:119], v3 offset:8944
    s_waitcnt lgkmcnt(7)
    v_mfma_f32_16x16x32_bf16 v[68:71], v[120:123], v[132:135], v[68:71]
    v_mfma_f32_16x16x32_bf16 v[84:87], v[124:127], v[132:135], v[84:87]
    v_mfma_f32_16x16x32_bf16 v[72:75], v[120:123], v[136:139], v[72:75]
    v_mfma_f32_16x16x32_bf16 v[88:91], v[124:127], v[136:139], v[88:91]
    v_mfma_f32_16x16x32_bf16 v[76:79], v[120:123], v[140:143], v[76:79]
    v_mfma_f32_16x16x32_bf16 v[92:95], v[124:127], v[140:143], v[92:95]
    ds_read2_b32 v[120:121], v2 offset0:16 offset1:17
    ds_read2_b32 v[122:123], v2 offset0:18 offset1:19
    ds_read2_b32 v[124:125], v2 offset0:24 offset1:25
    ds_read2_b32 v[126:127], v2 offset0:26 offset1:27
    ds_read_b128 v[132:135], v3 offset:8416
    ds_read_b128 v[136:139], v3 offset:8672
    ds_read_b128 v[140:143], v3 offset:8928
    s_waitcnt lgkmcnt(7)
    v_mfma_f32_16x16x32_bf16 v[68:71], v[96:99], v[108:111], v[68:71]
    v_mfma_f32_16x16x32_bf16 v[84:87], v[100:103], v[108:111], v[84:87]
    v_mfma_f32_16x16x32_bf16 v[72:75], v[96:99], v[112:115], v[72:75]
    v_mfma_f32_16x16x32_bf16 v[88:91], v[100:103], v[112:115], v[88:91]
    s_barrier
    v_mfma_f32_16x16x32_bf16 v[76:79], v[96:99], v[116:119], v[76:79]
    v_mfma_f32_16x16x32_bf16 v[92:95], v[100:103], v[116:119], v[92:95]
    ds_read2_b32 v[96:97], v2 offset0:32 offset1:33
    ds_read2_b32 v[98:99], v2 offset0:34 offset1:35
    ds_read2_b32 v[100:101], v2 offset0:40 offset1:41
    ds_read2_b32 v[102:103], v2 offset0:42 offset1:43
    ds_read_b128 v[108:111], v3 offset:8400
    ds_read_b128 v[112:115], v3 offset:8656
    ds_read_b128 v[116:119], v3 offset:8912
    s_waitcnt lgkmcnt(7)
    v_mfma_f32_16x16x32_bf16 v[68:71], v[120:123], v[132:135], v[68:71]
    v_mfma_f32_16x16x32_bf16 v[84:87], v[124:127], v[132:135], v[84:87]
    v_mfma_f32_16x16x32_bf16 v[72:75], v[120:123], v[136:139], v[72:75]
    v_mfma_f32_16x16x32_bf16 v[88:91], v[124:127], v[136:139], v[88:91]
    v_mfma_f32_16x16x32_bf16 v[76:79], v[120:123], v[140:143], v[76:79]
    v_mfma_f32_16x16x32_bf16 v[92:95], v[124:127], v[140:143], v[92:95]
    ds_read2_b32 v[120:121], v2 offset0:48 offset1:49
    ds_read2_b32 v[122:123], v2 offset0:50 offset1:51
    ds_read2_b32 v[124:125], v2 offset0:56 offset1:57
    ds_read2_b32 v[126:127], v2 offset0:58 offset1:59
    ds_read_b128 v[132:135], v3 offset:8384
    ds_read_b128 v[136:139], v3 offset:8640
    ds_read_b128 v[140:143], v3 offset:8896
    s_waitcnt lgkmcnt(7)
    v_mfma_f32_16x16x32_bf16 v[68:71], v[96:99], v[108:111], v[68:71]
    v_mfma_f32_16x16x32_bf16 v[84:87], v[100:103], v[108:111], v[84:87]
    v_mfma_f32_16x16x32_bf16 v[72:75], v[96:99], v[112:115], v[72:75]
    v_mfma_f32_16x16x32_bf16 v[88:91], v[100:103], v[112:115], v[88:91]
    s_barrier
    v_mfma_f32_16x16x32_bf16 v[76:79], v[96:99], v[116:119], v[76:79]
    v_mfma_f32_16x16x32_bf16 v[92:95], v[100:103], v[116:119], v[92:95]
    ds_read2_b32 v[96:97], v2 offset0:64 offset1:65
    ds_read2_b32 v[98:99], v2 offset0:66 offset1:67
    ds_read2_b32 v[100:101], v2 offset0:72 offset1:73
    ds_read2_b32 v[102:103], v2 offset0:74 offset1:75
    ds_read_b128 v[108:111], v3 offset:8368
    ds_read_b128 v[112:115], v3 offset:8624
    ds_read_b128 v[116:119], v3 offset:8880
    s_waitcnt lgkmcnt(7)
    v_mfma_f32_16x16x32_bf16 v[68:71], v[120:123], v[132:135], v[68:71]
    v_mfma_f32_16x16x32_bf16 v[84:87], v[124:127], v[132:135], v[84:87]
    v_mfma_f32_16x16x32_bf16 v[72:75], v[120:123], v[136:139], v[72:75]
    v_mfma_f32_16x16x32_bf16 v[88:91], v[124:127], v[136:139], v[88:91]
    v_mfma_f32_16x16x32_bf16 v[76:79], v[120:123], v[140:143], v[76:79]
    v_mfma_f32_16x16x32_bf16 v[92:95], v[124:127], v[140:143], v[92:95]
    ds_read2_b32 v[120:121], v2 offset0:80 offset1:81
    ds_read2_b32 v[122:123], v2 offset0:82 offset1:83
    ds_read2_b32 v[124:125], v2 offset0:88 offset1:89
    ds_read2_b32 v[126:127], v2 offset0:90 offset1:91
    ds_read_b128 v[132:135], v3 offset:8352
    ds_read_b128 v[136:139], v3 offset:8608
    ds_read_b128 v[140:143], v3 offset:8864
    s_waitcnt lgkmcnt(7)
    v_mfma_f32_16x16x32_bf16 v[68:71], v[96:99], v[108:111], v[68:71]
    v_mfma_f32_16x16x32_bf16 v[84:87], v[100:103], v[108:111], v[84:87]
    v_mfma_f32_16x16x32_bf16 v[72:75], v[96:99], v[112:115], v[72:75]
    v_mfma_f32_16x16x32_bf16 v[88:91], v[100:103], v[112:115], v[88:91]
    s_barrier
    v_mfma_f32_16x16x32_bf16 v[76:79], v[96:99], v[116:119], v[76:79]
    v_mfma_f32_16x16x32_bf16 v[92:95], v[100:103], v[116:119], v[92:95]
    ds_read2_b32 v[96:97], v2 offset0:96 offset1:97
    ds_read2_b32 v[98:99], v2 offset0:98 offset1:99
    ds_read2_b32 v[100:101], v2 offset0:104 offset1:105
    ds_read2_b32 v[102:103], v2 offset0:106 offset1:107
    ds_read_b128 v[108:111], v3 offset:8336
    ds_read_b128 v[112:115], v3 offset:8592
    ds_read_b128 v[116:119], v3 offset:8848
    s_waitcnt lgkmcnt(7)
    v_mfma_f32_16x16x32_bf16 v[68:71], v[120:123], v[132:135], v[68:71]
    v_mfma_f32_16x16x32_bf16 v[84:87], v[124:127], v[132:135], v[84:87]
    v_mfma_f32_16x16x32_bf16 v[72:75], v[120:123], v[136:139], v[72:75]
    v_mfma_f32_16x16x32_bf16 v[88:91], v[124:127], v[136:139], v[88:91]
    v_mfma_f32_16x16x32_bf16 v[76:79], v[120:123], v[140:143], v[76:79]
    v_mfma_f32_16x16x32_bf16 v[92:95], v[124:127], v[140:143], v[92:95]
    ds_read2_b32 v[120:121], v2 offset0:112 offset1:113
    ds_read2_b32 v[122:123], v2 offset0:114 offset1:115
    ds_read2_b32 v[124:125], v2 offset0:120 offset1:121
    ds_read2_b32 v[126:127], v2 offset0:122 offset1:123
    ds_read_b128 v[132:135], v3 offset:8320
    ds_read_b128 v[136:139], v3 offset:8576
    ds_read_b128 v[140:143], v3 offset:8832
    s_waitcnt lgkmcnt(7)
    v_mfma_f32_16x16x32_bf16 v[68:71], v[96:99], v[108:111], v[68:71]
    v_mfma_f32_16x16x32_bf16 v[84:87], v[100:103], v[108:111], v[84:87]
    v_mfma_f32_16x16x32_bf16 v[72:75], v[96:99], v[112:115], v[72:75]
    v_mfma_f32_16x16x32_bf16 v[88:91], v[100:103], v[112:115], v[88:91]
    s_barrier
    v_mfma_f32_16x16x32_bf16 v[76:79], v[96:99], v[116:119], v[76:79]
    v_mfma_f32_16x16x32_bf16 v[92:95], v[100:103], v[116:119], v[92:95]
    v_add_u32 v2, 512, v2
    ds_read2_b32 v[96:97], v2 offset0:0 offset1:1
    ds_read2_b32 v[98:99], v2 offset0:2 offset1:3
    ds_read2_b32 v[100:101], v2 offset0:8 offset1:9
    ds_read2_b32 v[102:103], v2 offset0:10 offset1:11
    ds_read_b128 v[112:115], v3 offset:8560
    ds_read_b128 v[116:119], v3 offset:8816
    s_waitcnt lgkmcnt(6)
    v_mfma_f32_16x16x32_bf16 v[68:71], v[120:123], v[132:135], v[68:71]
    v_mfma_f32_16x16x32_bf16 v[84:87], v[124:127], v[132:135], v[84:87]
    v_mfma_f32_16x16x32_bf16 v[72:75], v[120:123], v[136:139], v[72:75]
    v_mfma_f32_16x16x32_bf16 v[88:91], v[124:127], v[136:139], v[88:91]
    v_mfma_f32_16x16x32_bf16 v[76:79], v[120:123], v[140:143], v[76:79]
    v_mfma_f32_16x16x32_bf16 v[92:95], v[124:127], v[140:143], v[92:95]
    ds_read2_b32 v[120:121], v2 offset0:16 offset1:17
    ds_read2_b32 v[122:123], v2 offset0:18 offset1:19
    ds_read2_b32 v[124:125], v2 offset0:24 offset1:25
    ds_read2_b32 v[126:127], v2 offset0:26 offset1:27
    ds_read_b128 v[136:139], v3 offset:8544
    ds_read_b128 v[140:143], v3 offset:8800
    s_waitcnt lgkmcnt(6)
    v_mfma_f32_16x16x32_bf16 v[72:75], v[96:99], v[112:115], v[72:75]
    v_mfma_f32_16x16x32_bf16 v[88:91], v[100:103], v[112:115], v[88:91]
    v_mfma_f32_16x16x32_bf16 v[76:79], v[96:99], v[116:119], v[76:79]
    v_mfma_f32_16x16x32_bf16 v[92:95], v[100:103], v[116:119], v[92:95]
    s_barrier
    ds_read2_b32 v[96:97], v2 offset0:32 offset1:33
    ds_read2_b32 v[98:99], v2 offset0:34 offset1:35
    ds_read2_b32 v[100:101], v2 offset0:40 offset1:41
    ds_read2_b32 v[102:103], v2 offset0:42 offset1:43
    ds_read_b128 v[112:115], v3 offset:8528
    ds_read_b128 v[116:119], v3 offset:8784
    s_waitcnt lgkmcnt(6)
    v_mfma_f32_16x16x32_bf16 v[72:75], v[120:123], v[136:139], v[72:75]
    v_mfma_f32_16x16x32_bf16 v[88:91], v[124:127], v[136:139], v[88:91]
    v_mfma_f32_16x16x32_bf16 v[76:79], v[120:123], v[140:143], v[76:79]
    v_mfma_f32_16x16x32_bf16 v[92:95], v[124:127], v[140:143], v[92:95]
    ds_read2_b32 v[120:121], v2 offset0:48 offset1:49
    ds_read2_b32 v[122:123], v2 offset0:50 offset1:51
    ds_read2_b32 v[124:125], v2 offset0:56 offset1:57
    ds_read2_b32 v[126:127], v2 offset0:58 offset1:59
    ds_read_b128 v[136:139], v3 offset:8512
    ds_read_b128 v[140:143], v3 offset:8768
    s_waitcnt lgkmcnt(6)
    v_mfma_f32_16x16x32_bf16 v[72:75], v[96:99], v[112:115], v[72:75]
    v_mfma_f32_16x16x32_bf16 v[88:91], v[100:103], v[112:115], v[88:91]
    v_mfma_f32_16x16x32_bf16 v[76:79], v[96:99], v[116:119], v[76:79]
    v_mfma_f32_16x16x32_bf16 v[92:95], v[100:103], v[116:119], v[92:95]
    ds_read2_b32 v[96:97], v2 offset0:64 offset1:65
    ds_read2_b32 v[98:99], v2 offset0:66 offset1:67
    ds_read2_b32 v[100:101], v2 offset0:72 offset1:73
    ds_read2_b32 v[102:103], v2 offset0:74 offset1:75
    ds_read_b128 v[112:115], v3 offset:8496
    ds_read_b128 v[116:119], v3 offset:8752
    s_waitcnt lgkmcnt(6)
    v_mfma_f32_16x16x32_bf16 v[72:75], v[120:123], v[136:139], v[72:75]
    v_mfma_f32_16x16x32_bf16 v[88:91], v[124:127], v[136:139], v[88:91]
    v_mfma_f32_16x16x32_bf16 v[76:79], v[120:123], v[140:143], v[76:79]
    v_mfma_f32_16x16x32_bf16 v[92:95], v[124:127], v[140:143], v[92:95]
    s_barrier
    ds_read2_b32 v[120:121], v2 offset0:80 offset1:81
    ds_read2_b32 v[122:123], v2 offset0:82 offset1:83
    ds_read2_b32 v[124:125], v2 offset0:88 offset1:89
    ds_read2_b32 v[126:127], v2 offset0:90 offset1:91
    ds_read_b128 v[136:139], v3 offset:8480
    ds_read_b128 v[140:143], v3 offset:8736
    s_waitcnt lgkmcnt(6)
    v_mfma_f32_16x16x32_bf16 v[72:75], v[96:99], v[112:115], v[72:75]
    v_mfma_f32_16x16x32_bf16 v[88:91], v[100:103], v[112:115], v[88:91]
    v_mfma_f32_16x16x32_bf16 v[76:79], v[96:99], v[116:119], v[76:79]
    v_mfma_f32_16x16x32_bf16 v[92:95], v[100:103], v[116:119], v[92:95]
    ds_read2_b32 v[96:97], v2 offset0:96 offset1:97
    ds_read2_b32 v[98:99], v2 offset0:98 offset1:99
    ds_read2_b32 v[100:101], v2 offset0:104 offset1:105
    ds_read2_b32 v[102:103], v2 offset0:106 offset1:107
    ds_read_b128 v[112:115], v3 offset:8464
    ds_read_b128 v[116:119], v3 offset:8720
    s_waitcnt lgkmcnt(6)
    v_mfma_f32_16x16x32_bf16 v[72:75], v[120:123], v[136:139], v[72:75]
    v_mfma_f32_16x16x32_bf16 v[88:91], v[124:127], v[136:139], v[88:91]
    v_mfma_f32_16x16x32_bf16 v[76:79], v[120:123], v[140:143], v[76:79]
    v_mfma_f32_16x16x32_bf16 v[92:95], v[124:127], v[140:143], v[92:95]
    ds_read2_b32 v[120:121], v2 offset0:112 offset1:113
    ds_read2_b32 v[122:123], v2 offset0:114 offset1:115
    ds_read2_b32 v[124:125], v2 offset0:120 offset1:121
    ds_read2_b32 v[126:127], v2 offset0:122 offset1:123
    ds_read_b128 v[136:139], v3 offset:8448
    ds_read_b128 v[140:143], v3 offset:8704
    s_waitcnt lgkmcnt(6)
    v_mfma_f32_16x16x32_bf16 v[72:75], v[96:99], v[112:115], v[72:75]
    v_mfma_f32_16x16x32_bf16 v[88:91], v[100:103], v[112:115], v[88:91]
    v_mfma_f32_16x16x32_bf16 v[76:79], v[96:99], v[116:119], v[76:79]
    v_mfma_f32_16x16x32_bf16 v[92:95], v[100:103], v[116:119], v[92:95]
    s_barrier
    v_add_u32 v2, 512, v2
    ds_read2_b32 v[96:97], v2 offset0:0 offset1:1
    ds_read2_b32 v[98:99], v2 offset0:2 offset1:3
    ds_read2_b32 v[100:101], v2 offset0:8 offset1:9
    ds_read2_b32 v[102:103], v2 offset0:10 offset1:11
    ds_read_b128 v[112:115], v3 offset:8432
    ds_read_b128 v[116:119], v3 offset:8688
    s_waitcnt lgkmcnt(6)
    v_mfma_f32_16x16x32_bf16 v[72:75], v[120:123], v[136:139], v[72:75]
    v_mfma_f32_16x16x32_bf16 v[88:91], v[124:127], v[136:139], v[88:91]
    v_mfma_f32_16x16x32_bf16 v[76:79], v[120:123], v[140:143], v[76:79]
    v_mfma_f32_16x16x32_bf16 v[92:95], v[124:127], v[140:143], v[92:95]
    ds_read2_b32 v[120:121], v2 offset0:16 offset1:17
    ds_read2_b32 v[122:123], v2 offset0:18 offset1:19
    ds_read2_b32 v[124:125], v2 offset0:24 offset1:25
    ds_read2_b32 v[126:127], v2 offset0:26 offset1:27
    ds_read_b128 v[136:139], v3 offset:8416
    ds_read_b128 v[140:143], v3 offset:8672
    s_waitcnt lgkmcnt(6)
    v_mfma_f32_16x16x32_bf16 v[72:75], v[96:99], v[112:115], v[72:75]
    v_mfma_f32_16x16x32_bf16 v[88:91], v[100:103], v[112:115], v[88:91]
    v_mfma_f32_16x16x32_bf16 v[76:79], v[96:99], v[116:119], v[76:79]
    v_mfma_f32_16x16x32_bf16 v[92:95], v[100:103], v[116:119], v[92:95]
    ds_read2_b32 v[96:97], v2 offset0:32 offset1:33
    ds_read2_b32 v[98:99], v2 offset0:34 offset1:35
    ds_read2_b32 v[100:101], v2 offset0:40 offset1:41
    ds_read2_b32 v[102:103], v2 offset0:42 offset1:43
    ds_read_b128 v[112:115], v3 offset:8400
    ds_read_b128 v[116:119], v3 offset:8656
    s_waitcnt lgkmcnt(6)
    v_mfma_f32_16x16x32_bf16 v[72:75], v[120:123], v[136:139], v[72:75]
    v_mfma_f32_16x16x32_bf16 v[88:91], v[124:127], v[136:139], v[88:91]
    v_mfma_f32_16x16x32_bf16 v[76:79], v[120:123], v[140:143], v[76:79]
    v_mfma_f32_16x16x32_bf16 v[92:95], v[124:127], v[140:143], v[92:95]
    s_barrier
    ds_read2_b32 v[120:121], v2 offset0:48 offset1:49
    ds_read2_b32 v[122:123], v2 offset0:50 offset1:51
    ds_read2_b32 v[124:125], v2 offset0:56 offset1:57
    ds_read2_b32 v[126:127], v2 offset0:58 offset1:59
    ds_read_b128 v[136:139], v3 offset:8384
    ds_read_b128 v[140:143], v3 offset:8640
    s_waitcnt lgkmcnt(6)
    v_mfma_f32_16x16x32_bf16 v[72:75], v[96:99], v[112:115], v[72:75]
    v_mfma_f32_16x16x32_bf16 v[88:91], v[100:103], v[112:115], v[88:91]
    v_mfma_f32_16x16x32_bf16 v[76:79], v[96:99], v[116:119], v[76:79]
    v_mfma_f32_16x16x32_bf16 v[92:95], v[100:103], v[116:119], v[92:95]
    ds_read2_b32 v[96:97], v2 offset0:64 offset1:65
    ds_read2_b32 v[98:99], v2 offset0:66 offset1:67
    ds_read2_b32 v[100:101], v2 offset0:72 offset1:73
    ds_read2_b32 v[102:103], v2 offset0:74 offset1:75
    ds_read_b128 v[112:115], v3 offset:8368
    ds_read_b128 v[116:119], v3 offset:8624
    s_waitcnt lgkmcnt(6)
    v_mfma_f32_16x16x32_bf16 v[72:75], v[120:123], v[136:139], v[72:75]
    v_mfma_f32_16x16x32_bf16 v[88:91], v[124:127], v[136:139], v[88:91]
    v_mfma_f32_16x16x32_bf16 v[76:79], v[120:123], v[140:143], v[76:79]
    v_mfma_f32_16x16x32_bf16 v[92:95], v[124:127], v[140:143], v[92:95]
    ds_read2_b32 v[120:121], v2 offset0:80 offset1:81
    ds_read2_b32 v[122:123], v2 offset0:82 offset1:83
    ds_read2_b32 v[124:125], v2 offset0:88 offset1:89
    ds_read2_b32 v[126:127], v2 offset0:90 offset1:91
    ds_read_b128 v[136:139], v3 offset:8352
    ds_read_b128 v[140:143], v3 offset:8608
    s_waitcnt lgkmcnt(6)
    v_mfma_f32_16x16x32_bf16 v[72:75], v[96:99], v[112:115], v[72:75]
    v_mfma_f32_16x16x32_bf16 v[88:91], v[100:103], v[112:115], v[88:91]
    v_mfma_f32_16x16x32_bf16 v[76:79], v[96:99], v[116:119], v[76:79]
    v_mfma_f32_16x16x32_bf16 v[92:95], v[100:103], v[116:119], v[92:95]
    s_barrier
    ds_read2_b32 v[96:97], v2 offset0:96 offset1:97
    ds_read2_b32 v[98:99], v2 offset0:98 offset1:99
    ds_read2_b32 v[100:101], v2 offset0:104 offset1:105
    ds_read2_b32 v[102:103], v2 offset0:106 offset1:107
    ds_read_b128 v[112:115], v3 offset:8336
    ds_read_b128 v[116:119], v3 offset:8592
    s_waitcnt lgkmcnt(6)
    v_mfma_f32_16x16x32_bf16 v[72:75], v[120:123], v[136:139], v[72:75]
    v_mfma_f32_16x16x32_bf16 v[88:91], v[124:127], v[136:139], v[88:91]
    v_mfma_f32_16x16x32_bf16 v[76:79], v[120:123], v[140:143], v[76:79]
    v_mfma_f32_16x16x32_bf16 v[92:95], v[124:127], v[140:143], v[92:95]
    ds_read2_b32 v[120:121], v2 offset0:112 offset1:113
    ds_read2_b32 v[122:123], v2 offset0:114 offset1:115
    ds_read2_b32 v[124:125], v2 offset0:120 offset1:121
    ds_read2_b32 v[126:127], v2 offset0:122 offset1:123
    ds_read_b128 v[136:139], v3 offset:8320
    ds_read_b128 v[140:143], v3 offset:8576
    s_waitcnt lgkmcnt(6)
    v_mfma_f32_16x16x32_bf16 v[72:75], v[96:99], v[112:115], v[72:75]
    v_mfma_f32_16x16x32_bf16 v[88:91], v[100:103], v[112:115], v[88:91]
    v_mfma_f32_16x16x32_bf16 v[76:79], v[96:99], v[116:119], v[76:79]
    v_mfma_f32_16x16x32_bf16 v[92:95], v[100:103], v[116:119], v[92:95]
    v_add_u32 v2, 512, v2
    ds_read2_b32 v[96:97], v2 offset0:0 offset1:1
    ds_read2_b32 v[98:99], v2 offset0:2 offset1:3
    ds_read2_b32 v[100:101], v2 offset0:8 offset1:9
    ds_read2_b32 v[102:103], v2 offset0:10 offset1:11
    ds_read_b128 v[116:119], v3 offset:8560
    s_waitcnt lgkmcnt(5)
    v_mfma_f32_16x16x32_bf16 v[72:75], v[120:123], v[136:139], v[72:75]
    v_mfma_f32_16x16x32_bf16 v[88:91], v[124:127], v[136:139], v[88:91]
    v_mfma_f32_16x16x32_bf16 v[76:79], v[120:123], v[140:143], v[76:79]
    v_mfma_f32_16x16x32_bf16 v[92:95], v[124:127], v[140:143], v[92:95]
    s_barrier
    ds_read2_b32 v[120:121], v2 offset0:16 offset1:17
    ds_read2_b32 v[122:123], v2 offset0:18 offset1:19
    ds_read2_b32 v[124:125], v2 offset0:24 offset1:25
    ds_read2_b32 v[126:127], v2 offset0:26 offset1:27
    ds_read_b128 v[140:143], v3 offset:8544
    s_waitcnt lgkmcnt(5)
    v_mfma_f32_16x16x32_bf16 v[76:79], v[96:99], v[116:119], v[76:79]
    v_mfma_f32_16x16x32_bf16 v[92:95], v[100:103], v[116:119], v[92:95]
    ds_read2_b32 v[96:97], v2 offset0:32 offset1:33
    ds_read2_b32 v[98:99], v2 offset0:34 offset1:35
    ds_read2_b32 v[100:101], v2 offset0:40 offset1:41
    ds_read2_b32 v[102:103], v2 offset0:42 offset1:43
    ds_read_b128 v[116:119], v3 offset:8528
    s_waitcnt lgkmcnt(5)
    v_mfma_f32_16x16x32_bf16 v[76:79], v[120:123], v[140:143], v[76:79]
    v_mfma_f32_16x16x32_bf16 v[92:95], v[124:127], v[140:143], v[92:95]
    ds_read2_b32 v[120:121], v2 offset0:48 offset1:49
    ds_read2_b32 v[122:123], v2 offset0:50 offset1:51
    ds_read2_b32 v[124:125], v2 offset0:56 offset1:57
    ds_read2_b32 v[126:127], v2 offset0:58 offset1:59
    ds_read_b128 v[140:143], v3 offset:8512
    s_waitcnt lgkmcnt(5)
    v_mfma_f32_16x16x32_bf16 v[76:79], v[96:99], v[116:119], v[76:79]
    v_mfma_f32_16x16x32_bf16 v[92:95], v[100:103], v[116:119], v[92:95]
    ds_read2_b32 v[96:97], v2 offset0:64 offset1:65
    ds_read2_b32 v[98:99], v2 offset0:66 offset1:67
    ds_read2_b32 v[100:101], v2 offset0:72 offset1:73
    ds_read2_b32 v[102:103], v2 offset0:74 offset1:75
    ds_read_b128 v[116:119], v3 offset:8496
    s_waitcnt lgkmcnt(5)
    v_mfma_f32_16x16x32_bf16 v[76:79], v[120:123], v[140:143], v[76:79]
    v_mfma_f32_16x16x32_bf16 v[92:95], v[124:127], v[140:143], v[92:95]
    ds_read2_b32 v[120:121], v2 offset0:80 offset1:81
    ds_read2_b32 v[122:123], v2 offset0:82 offset1:83
    ds_read2_b32 v[124:125], v2 offset0:88 offset1:89
    ds_read2_b32 v[126:127], v2 offset0:90 offset1:91
    ds_read_b128 v[140:143], v3 offset:8480
    s_waitcnt lgkmcnt(5)
    v_mfma_f32_16x16x32_bf16 v[76:79], v[96:99], v[116:119], v[76:79]
    v_mfma_f32_16x16x32_bf16 v[92:95], v[100:103], v[116:119], v[92:95]
    ds_read2_b32 v[96:97], v2 offset0:96 offset1:97
    ds_read2_b32 v[98:99], v2 offset0:98 offset1:99
    ds_read2_b32 v[100:101], v2 offset0:104 offset1:105
    ds_read2_b32 v[102:103], v2 offset0:106 offset1:107
    ds_read_b128 v[116:119], v3 offset:8464
    s_waitcnt lgkmcnt(5)
    v_mfma_f32_16x16x32_bf16 v[76:79], v[120:123], v[140:143], v[76:79]
    v_mfma_f32_16x16x32_bf16 v[92:95], v[124:127], v[140:143], v[92:95]
    s_barrier
    ds_read2_b32 v[120:121], v2 offset0:112 offset1:113
    ds_read2_b32 v[122:123], v2 offset0:114 offset1:115
    ds_read2_b32 v[124:125], v2 offset0:120 offset1:121
    ds_read2_b32 v[126:127], v2 offset0:122 offset1:123
    ds_read_b128 v[140:143], v3 offset:8448
    s_waitcnt lgkmcnt(5)
    v_mfma_f32_16x16x32_bf16 v[76:79], v[96:99], v[116:119], v[76:79]
    v_mfma_f32_16x16x32_bf16 v[92:95], v[100:103], v[116:119], v[92:95]
    v_add_u32 v2, 512, v2
    ds_read2_b32 v[96:97], v2 offset0:0 offset1:1
    ds_read2_b32 v[98:99], v2 offset0:2 offset1:3
    ds_read2_b32 v[100:101], v2 offset0:8 offset1:9
    ds_read2_b32 v[102:103], v2 offset0:10 offset1:11
    ds_read_b128 v[116:119], v3 offset:8432
    s_waitcnt lgkmcnt(5)
    v_mfma_f32_16x16x32_bf16 v[76:79], v[120:123], v[140:143], v[76:79]
    v_mfma_f32_16x16x32_bf16 v[92:95], v[124:127], v[140:143], v[92:95]
    ds_read2_b32 v[120:121], v2 offset0:16 offset1:17
    ds_read2_b32 v[122:123], v2 offset0:18 offset1:19
    ds_read2_b32 v[124:125], v2 offset0:24 offset1:25
    ds_read2_b32 v[126:127], v2 offset0:26 offset1:27
    ds_read_b128 v[140:143], v3 offset:8416
    s_waitcnt lgkmcnt(5)
    v_mfma_f32_16x16x32_bf16 v[76:79], v[96:99], v[116:119], v[76:79]
    v_mfma_f32_16x16x32_bf16 v[92:95], v[100:103], v[116:119], v[92:95]
    ds_read2_b32 v[96:97], v2 offset0:32 offset1:33
    ds_read2_b32 v[98:99], v2 offset0:34 offset1:35
    ds_read2_b32 v[100:101], v2 offset0:40 offset1:41
    ds_read2_b32 v[102:103], v2 offset0:42 offset1:43
    ds_read_b128 v[116:119], v3 offset:8400
    s_waitcnt lgkmcnt(5)
    v_mfma_f32_16x16x32_bf16 v[76:79], v[120:123], v[140:143], v[76:79]
    v_mfma_f32_16x16x32_bf16 v[92:95], v[124:127], v[140:143], v[92:95]
    ds_read2_b32 v[120:121], v2 offset0:48 offset1:49
    ds_read2_b32 v[122:123], v2 offset0:50 offset1:51
    ds_read2_b32 v[124:125], v2 offset0:56 offset1:57
    ds_read2_b32 v[126:127], v2 offset0:58 offset1:59
    ds_read_b128 v[140:143], v3 offset:8384
    s_waitcnt lgkmcnt(5)
    v_mfma_f32_16x16x32_bf16 v[76:79], v[96:99], v[116:119], v[76:79]
    v_mfma_f32_16x16x32_bf16 v[92:95], v[100:103], v[116:119], v[92:95]
    ds_read2_b32 v[96:97], v2 offset0:64 offset1:65
    ds_read2_b32 v[98:99], v2 offset0:66 offset1:67
    ds_read2_b32 v[100:101], v2 offset0:72 offset1:73
    ds_read2_b32 v[102:103], v2 offset0:74 offset1:75
    ds_read_b128 v[116:119], v3 offset:8368
    s_waitcnt lgkmcnt(5)
    v_mfma_f32_16x16x32_bf16 v[76:79], v[120:123], v[140:143], v[76:79]
    v_mfma_f32_16x16x32_bf16 v[92:95], v[124:127], v[140:143], v[92:95]
    s_barrier
    ds_read2_b32 v[120:121], v2 offset0:80 offset1:81
    ds_read2_b32 v[122:123], v2 offset0:82 offset1:83
    ds_read2_b32 v[124:125], v2 offset0:88 offset1:89
    ds_read2_b32 v[126:127], v2 offset0:90 offset1:91
    ds_read_b128 v[140:143], v3 offset:8352
    s_waitcnt lgkmcnt(5)
    v_mfma_f32_16x16x32_bf16 v[76:79], v[96:99], v[116:119], v[76:79]
    v_mfma_f32_16x16x32_bf16 v[92:95], v[100:103], v[116:119], v[92:95]
    ds_read2_b32 v[96:97], v2 offset0:96 offset1:97
    ds_read2_b32 v[98:99], v2 offset0:98 offset1:99
    ds_read2_b32 v[100:101], v2 offset0:104 offset1:105
    ds_read2_b32 v[102:103], v2 offset0:106 offset1:107
    ds_read_b128 v[116:119], v3 offset:8336
    s_waitcnt lgkmcnt(5)
    v_mfma_f32_16x16x32_bf16 v[76:79], v[120:123], v[140:143], v[76:79]
    v_mfma_f32_16x16x32_bf16 v[92:95], v[124:127], v[140:143], v[92:95]
    ds_read2_b32 v[120:121], v2 offset0:112 offset1:113
    ds_read2_b32 v[122:123], v2 offset0:114 offset1:115
    ds_read2_b32 v[124:125], v2 offset0:120 offset1:121
    ds_read2_b32 v[126:127], v2 offset0:122 offset1:123
    ds_read_b128 v[140:143], v3 offset:8320
    s_waitcnt lgkmcnt(5)
    v_mfma_f32_16x16x32_bf16 v[76:79], v[96:99], v[116:119], v[76:79]
    v_mfma_f32_16x16x32_bf16 v[92:95], v[100:103], v[116:119], v[92:95]
    s_waitcnt lgkmcnt(0)
    v_mfma_f32_16x16x32_bf16 v[76:79], v[120:123], v[140:143], v[76:79]
    v_mfma_f32_16x16x32_bf16 v[92:95], v[124:127], v[140:143], v[92:95]
    s_and_b32 s38, s33, 1
    s_lshl_b32 s38, s38, 4
    s_lshr_b32 s37, s37, s38
    s_lshl_b32 s37, s37, 16
    v_lshrrev_b32 v6, 1, v4
    v_mul_u32_u24 v6, 1280, v6
    v_and_b32 v7, 1, v4
    v_xor_b32 v7, 1, v7
    v_lshlrev_b32 v7, 3, v7
    v_lshlrev_b32 v8, 4, v5
    v_add3_u32 v6, v6, v7, v8
    v_add_u32 v6, s35, v6
    v_lshlrev_b32 v8, 6, v5
    v_lshlrev_b32 v9, 3, v4
    v_add_u32 v8, v8, v9
    s_nop 7
    s_nop 7

    ds_read_b64 v[96:97], v6 offset:8576
    ds_read_b64 v[98:99], v6 offset:8832
    ds_read_b64 v[100:101], v6 offset:9088
    ds_read_b64 v[102:103], v6 offset:9344
    ds_read_b64 v[104:105], v6 offset:11136
    ds_read_b64 v[106:107], v6 offset:11392
    ds_read_b64 v[108:109], v6 offset:11648
    ds_read_b64 v[110:111], v6 offset:11904
    s_waitcnt lgkmcnt(0)
    v_and_b32 v10, v1, v97
    v_lshlrev_b32 v11, 16, v97
    v_and_b32 v12, v1, v96
    v_lshlrev_b32 v13, 16, v96
    v_mul_f32 v10, s37, v10
    v_mul_f32 v11, s37, v11
    v_mul_f32 v12, s37, v12
    v_mul_f32 v13, s37, v13
    v_cvt_pk_bf16_f32 v14, v10, v11
    v_cvt_pk_bf16_f32 v15, v12, v13
    v_cvt_pk_bf16_f32 v16, v64, v65
    v_cvt_pk_bf16_f32 v17, v66, v67
    v_lshlrev_b32 v10, 16, v14
    v_and_b32 v11, v1, v14
    v_lshlrev_b32 v12, 16, v15
    v_and_b32 v13, v1, v15
    v_lshlrev_b32 v18, 16, v16
    v_and_b32 v19, v1, v16
    v_lshlrev_b32 v20, 16, v17
    v_and_b32 v21, v1, v17
    v_pk_add_f32 v[10:11], v[10:11], v[18:19]
    v_pk_add_f32 v[12:13], v[12:13], v[20:21]
    v_cvt_pk_bf16_f32 v96, v10, v11
    v_cvt_pk_bf16_f32 v97, v12, v13
    buffer_store_dwordx2 v[96:97], v8, s[24:27], 0 offen offset:0

    v_and_b32 v10, v1, v99
    v_lshlrev_b32 v11, 16, v99
    v_and_b32 v12, v1, v98
    v_lshlrev_b32 v13, 16, v98
    v_mul_f32 v10, s37, v10
    v_mul_f32 v11, s37, v11
    v_mul_f32 v12, s37, v12
    v_mul_f32 v13, s37, v13
    v_cvt_pk_bf16_f32 v14, v10, v11
    v_cvt_pk_bf16_f32 v15, v12, v13
    v_cvt_pk_bf16_f32 v16, v68, v69
    v_cvt_pk_bf16_f32 v17, v70, v71
    v_lshlrev_b32 v10, 16, v14
    v_and_b32 v11, v1, v14
    v_lshlrev_b32 v12, 16, v15
    v_and_b32 v13, v1, v15
    v_lshlrev_b32 v18, 16, v16
    v_and_b32 v19, v1, v16
    v_lshlrev_b32 v20, 16, v17
    v_and_b32 v21, v1, v17
    v_pk_add_f32 v[10:11], v[10:11], v[18:19]
    v_pk_add_f32 v[12:13], v[12:13], v[20:21]
    v_cvt_pk_bf16_f32 v98, v10, v11
    v_cvt_pk_bf16_f32 v99, v12, v13
    buffer_store_dwordx2 v[98:99], v8, s[24:27], 0 offen offset:1024

    v_and_b32 v10, v1, v101
    v_lshlrev_b32 v11, 16, v101
    v_and_b32 v12, v1, v100
    v_lshlrev_b32 v13, 16, v100
    v_mul_f32 v10, s37, v10
    v_mul_f32 v11, s37, v11
    v_mul_f32 v12, s37, v12
    v_mul_f32 v13, s37, v13
    v_cvt_pk_bf16_f32 v14, v10, v11
    v_cvt_pk_bf16_f32 v15, v12, v13
    v_cvt_pk_bf16_f32 v16, v72, v73
    v_cvt_pk_bf16_f32 v17, v74, v75
    v_lshlrev_b32 v10, 16, v14
    v_and_b32 v11, v1, v14
    v_lshlrev_b32 v12, 16, v15
    v_and_b32 v13, v1, v15
    v_lshlrev_b32 v18, 16, v16
    v_and_b32 v19, v1, v16
    v_lshlrev_b32 v20, 16, v17
    v_and_b32 v21, v1, v17
    v_pk_add_f32 v[10:11], v[10:11], v[18:19]
    v_pk_add_f32 v[12:13], v[12:13], v[20:21]
    v_cvt_pk_bf16_f32 v100, v10, v11
    v_cvt_pk_bf16_f32 v101, v12, v13
    buffer_store_dwordx2 v[100:101], v8, s[24:27], 0 offen offset:2048

    v_and_b32 v10, v1, v103
    v_lshlrev_b32 v11, 16, v103
    v_and_b32 v12, v1, v102
    v_lshlrev_b32 v13, 16, v102
    v_mul_f32 v10, s37, v10
    v_mul_f32 v11, s37, v11
    v_mul_f32 v12, s37, v12
    v_mul_f32 v13, s37, v13
    v_cvt_pk_bf16_f32 v14, v10, v11
    v_cvt_pk_bf16_f32 v15, v12, v13
    v_cvt_pk_bf16_f32 v16, v76, v77
    v_cvt_pk_bf16_f32 v17, v78, v79
    v_lshlrev_b32 v10, 16, v14
    v_and_b32 v11, v1, v14
    v_lshlrev_b32 v12, 16, v15
    v_and_b32 v13, v1, v15
    v_lshlrev_b32 v18, 16, v16
    v_and_b32 v19, v1, v16
    v_lshlrev_b32 v20, 16, v17
    v_and_b32 v21, v1, v17
    v_pk_add_f32 v[10:11], v[10:11], v[18:19]
    v_pk_add_f32 v[12:13], v[12:13], v[20:21]
    v_cvt_pk_bf16_f32 v102, v10, v11
    v_cvt_pk_bf16_f32 v103, v12, v13
    buffer_store_dwordx2 v[102:103], v8, s[24:27], 0 offen offset:3072

    v_and_b32 v10, v1, v105
    v_lshlrev_b32 v11, 16, v105
    v_and_b32 v12, v1, v104
    v_lshlrev_b32 v13, 16, v104
    v_mul_f32 v10, s37, v10
    v_mul_f32 v11, s37, v11
    v_mul_f32 v12, s37, v12
    v_mul_f32 v13, s37, v13
    v_cvt_pk_bf16_f32 v14, v10, v11
    v_cvt_pk_bf16_f32 v15, v12, v13
    v_cvt_pk_bf16_f32 v16, v80, v81
    v_cvt_pk_bf16_f32 v17, v82, v83
    v_lshlrev_b32 v10, 16, v14
    v_and_b32 v11, v1, v14
    v_lshlrev_b32 v12, 16, v15
    v_and_b32 v13, v1, v15
    v_lshlrev_b32 v18, 16, v16
    v_and_b32 v19, v1, v16
    v_lshlrev_b32 v20, 16, v17
    v_and_b32 v21, v1, v17
    v_pk_add_f32 v[10:11], v[10:11], v[18:19]
    v_pk_add_f32 v[12:13], v[12:13], v[20:21]
    v_cvt_pk_bf16_f32 v104, v10, v11
    v_cvt_pk_bf16_f32 v105, v12, v13
    buffer_store_dwordx2 v[104:105], v8, s[24:27], 0 offen offset:32

    v_and_b32 v10, v1, v107
    v_lshlrev_b32 v11, 16, v107
    v_and_b32 v12, v1, v106
    v_lshlrev_b32 v13, 16, v106
    v_mul_f32 v10, s37, v10
    v_mul_f32 v11, s37, v11
    v_mul_f32 v12, s37, v12
    v_mul_f32 v13, s37, v13
    v_cvt_pk_bf16_f32 v14, v10, v11
    v_cvt_pk_bf16_f32 v15, v12, v13
    v_cvt_pk_bf16_f32 v16, v84, v85
    v_cvt_pk_bf16_f32 v17, v86, v87
    v_lshlrev_b32 v10, 16, v14
    v_and_b32 v11, v1, v14
    v_lshlrev_b32 v12, 16, v15
    v_and_b32 v13, v1, v15
    v_lshlrev_b32 v18, 16, v16
    v_and_b32 v19, v1, v16
    v_lshlrev_b32 v20, 16, v17
    v_and_b32 v21, v1, v17
    v_pk_add_f32 v[10:11], v[10:11], v[18:19]
    v_pk_add_f32 v[12:13], v[12:13], v[20:21]
    v_cvt_pk_bf16_f32 v106, v10, v11
    v_cvt_pk_bf16_f32 v107, v12, v13
    buffer_store_dwordx2 v[106:107], v8, s[24:27], 0 offen offset:1056

    v_and_b32 v10, v1, v109
    v_lshlrev_b32 v11, 16, v109
    v_and_b32 v12, v1, v108
    v_lshlrev_b32 v13, 16, v108
    v_mul_f32 v10, s37, v10
    v_mul_f32 v11, s37, v11
    v_mul_f32 v12, s37, v12
    v_mul_f32 v13, s37, v13
    v_cvt_pk_bf16_f32 v14, v10, v11
    v_cvt_pk_bf16_f32 v15, v12, v13
    v_cvt_pk_bf16_f32 v16, v88, v89
    v_cvt_pk_bf16_f32 v17, v90, v91
    v_lshlrev_b32 v10, 16, v14
    v_and_b32 v11, v1, v14
    v_lshlrev_b32 v12, 16, v15
    v_and_b32 v13, v1, v15
    v_lshlrev_b32 v18, 16, v16
    v_and_b32 v19, v1, v16
    v_lshlrev_b32 v20, 16, v17
    v_and_b32 v21, v1, v17
    v_pk_add_f32 v[10:11], v[10:11], v[18:19]
    v_pk_add_f32 v[12:13], v[12:13], v[20:21]
    v_cvt_pk_bf16_f32 v108, v10, v11
    v_cvt_pk_bf16_f32 v109, v12, v13
    buffer_store_dwordx2 v[108:109], v8, s[24:27], 0 offen offset:2080

    v_and_b32 v10, v1, v111
    v_lshlrev_b32 v11, 16, v111
    v_and_b32 v12, v1, v110
    v_lshlrev_b32 v13, 16, v110
    v_mul_f32 v10, s37, v10
    v_mul_f32 v11, s37, v11
    v_mul_f32 v12, s37, v12
    v_mul_f32 v13, s37, v13
    v_cvt_pk_bf16_f32 v14, v10, v11
    v_cvt_pk_bf16_f32 v15, v12, v13
    v_cvt_pk_bf16_f32 v16, v92, v93
    v_cvt_pk_bf16_f32 v17, v94, v95
    v_lshlrev_b32 v10, 16, v14
    v_and_b32 v11, v1, v14
    v_lshlrev_b32 v12, 16, v15
    v_and_b32 v13, v1, v15
    v_lshlrev_b32 v18, 16, v16
    v_and_b32 v19, v1, v16
    v_lshlrev_b32 v20, 16, v17
    v_and_b32 v21, v1, v17
    v_pk_add_f32 v[10:11], v[10:11], v[18:19]
    v_pk_add_f32 v[12:13], v[12:13], v[20:21]
    v_cvt_pk_bf16_f32 v110, v10, v11
    v_cvt_pk_bf16_f32 v111, v12, v13
    buffer_store_dwordx2 v[110:111], v8, s[24:27], 0 offen offset:3104

    s_endpgm
.globl gemm2_kernel
.p2align 8
.type gemm2_kernel,@function
gemm2_kernel:
    s_load_dwordx2 s[4:5], s[0:1], 104
    s_load_dwordx4 s[8:11], s[0:1], 72
    s_cmp_ge_u32 s2, 256
    s_cbranch_scc1 gemm2_kernel_done
    v_lshrrev_b32 v1, 6, v0
    v_and_b32 v0, 63, v0
    s_and_b32 s33, s2, 7
    v_readfirstlane_b32 s31, v1
    s_lshr_b32 s34, s2, 3
    s_and_b32 s35, s33, 1
    s_lshl_b32 s35, s35, 2
    s_and_b32 s36, s34, 3
    s_add_u32 s35, s35, s36
    s_lshr_b32 s36, s33, 1
    s_mul_i32 s36, s36, 8
    s_lshr_b32 s37, s34, 2
    s_add_u32 s36, s36, s37
    s_lshl_b32 s35, s35, 7
    s_mul_i32 s36, s36, 64
    s_and_b32 s32, s31, 3
    v_lshrrev_b32 v2, 4, v0
    v_and_b32 v3, 15, v0
    s_cmp_ge_u32 s31, 8
    s_cbranch_scc1 gemm2_kernel_conv
    s_cmp_ge_u32 s34, 32
    s_cbranch_scc1 gemm2_kernel_helper
    s_cmp_lt_u32 s31, 4
    s_cbranch_scc1 gemm2_kernel_compute

    s_lshl_b32 s40, s32, 4
    s_lshl_b32 s41, s35, 7
    s_lshl_b32 s42, s36, 1
    v_add_u32 v4, s40, v2

    v_add_u32 v5, 0, v2
    v_and_b32 v5, 7, v5
    v_lshlrev_b32 v5, 1, v5
    v_xor_b32 v5, v5, v3
    v_lshlrev_b32 v6, 8, v4
    v_lshl_add_u32 v6, v5, 4, v6
    v_add_u32 v10, s41, v6

    v_add_u32 v5, 4, v2
    v_and_b32 v5, 7, v5
    v_lshlrev_b32 v5, 1, v5
    v_xor_b32 v5, v5, v3
    v_lshlrev_b32 v6, 8, v4
    v_lshl_add_u32 v6, v5, 4, v6
    v_add_u32 v11, s41, v6

    v_add_u32 v5, 8, v2
    v_and_b32 v5, 7, v5
    v_lshlrev_b32 v5, 1, v5
    v_xor_b32 v5, v5, v3
    v_lshlrev_b32 v6, 8, v4
    v_lshl_add_u32 v6, v5, 4, v6
    v_add_u32 v12, s41, v6

    v_add_u32 v5, 12, v2
    v_and_b32 v5, 7, v5
    v_lshlrev_b32 v5, 1, v5
    v_xor_b32 v5, v5, v3
    v_lshlrev_b32 v6, 8, v4
    v_lshl_add_u32 v6, v5, 4, v6
    v_add_u32 v13, s41, v6

    v_lshrrev_b32 v8, 3, v0
    v_and_b32 v9, 7, v0
    s_lshl_b32 s47, s32, 11
    s_add_u32 s47, s47, 16384
    s_lshr_b32 s43, s34, 2
    s_cmp_eq_u32 s43, 3
    s_cselect_b32 s51, 7, 12
    s_cselect_b32 s42, 0, s42
    s_lshl_b32 s52, 64, s51

    v_add_u32 v4, 0, v8
    v_add_u32 v4, s40, v4
    v_bfe_u32 v5, v4, 1, 2
    v_lshlrev_b32 v5, 1, v5
    v_xor_b32 v5, v5, v9
    v_lshlrev_b32 v6, s51, v4
    v_lshl_add_u32 v6, v5, 4, v6
    v_add_u32 v6, s42, v6
    v_subrev_u32 v14, 0, v6

    v_add_u32 v4, 8, v8
    v_add_u32 v4, s40, v4
    v_bfe_u32 v5, v4, 1, 2
    v_lshlrev_b32 v5, 1, v5
    v_xor_b32 v5, v5, v9
    v_lshlrev_b32 v6, s51, v4
    v_lshl_add_u32 v6, v5, 4, v6
    v_add_u32 v6, s42, v6
    v_subrev_u32 v15, 1024, v6

    s_lshl_b32 s46, s32, 12
    s_mov_b32 s48, 0
    s_mov_b32 s49, 0
    s_waitcnt lgkmcnt(0)

    s_add_u32 s16, s4, 0xc00000
    s_addc_u32 s17, s5, 0
    s_and_b32 s17, s17, 0xffff
    s_mov_b32 s18, 0x700000
    s_mov_b32 s19, 0x20000
    s_mov_b32 s20, s8
    s_mov_b32 s21, s9
    s_and_b32 s21, s21, 0xffff
    s_mov_b32 s22, 0xe00000
    s_mov_b32 s23, 0x20000
    s_lshr_b32 s43, s33, 1
    s_mul_i32 s43, s43, 458752
    s_add_u32 s43, s43, 22020096
    s_add_u32 s44, s4, s43
    s_addc_u32 s45, s5, 0
    s_and_b32 s45, s45, 0xffff
    s_cmp_eq_u32 s51, 7
    s_cselect_b32 s20, s44, s20
    s_cselect_b32 s21, s45, s21
    s_cselect_b32 s22, 458752, s22

    s_add_u32 m0, s46, 0
    s_nop 0
    buffer_load_dwordx4 v10, s[16:19], s48 offen offset:0 lds
    buffer_load_dwordx4 v11, s[16:19], s48 offen offset:1024 lds
    buffer_load_dwordx4 v12, s[16:19], s48 offen offset:2048 lds
    buffer_load_dwordx4 v13, s[16:19], s48 offen offset:3072 lds
    s_add_u32 m0, s47, 0
    s_nop 0
    buffer_load_dwordx4 v14, s[20:23], s49 offen offset:0 lds
    buffer_load_dwordx4 v15, s[20:23], s49 offen offset:1024 lds
    s_add_u32 s48, s48, 131072
    s_add_u32 s49, s49, s52
    s_add_u32 m0, s46, 24576
    s_nop 0
    buffer_load_dwordx4 v10, s[16:19], s48 offen offset:0 lds
    buffer_load_dwordx4 v11, s[16:19], s48 offen offset:1024 lds
    buffer_load_dwordx4 v12, s[16:19], s48 offen offset:2048 lds
    buffer_load_dwordx4 v13, s[16:19], s48 offen offset:3072 lds
    s_add_u32 m0, s47, 24576
    s_nop 0
    buffer_load_dwordx4 v14, s[20:23], s49 offen offset:0 lds
    buffer_load_dwordx4 v15, s[20:23], s49 offen offset:1024 lds
    s_add_u32 s48, s48, 131072
    s_add_u32 s49, s49, s52
    s_waitcnt vmcnt(6)
    s_barrier
    s_add_u32 m0, s46, 49152
    s_nop 0
    buffer_load_dwordx4 v10, s[16:19], s48 offen offset:0 lds
    buffer_load_dwordx4 v11, s[16:19], s48 offen offset:1024 lds
    buffer_load_dwordx4 v12, s[16:19], s48 offen offset:2048 lds
    buffer_load_dwordx4 v13, s[16:19], s48 offen offset:3072 lds
    s_add_u32 m0, s47, 49152
    s_nop 0
    buffer_load_dwordx4 v14, s[20:23], s49 offen offset:0 lds
    buffer_load_dwordx4 v15, s[20:23], s49 offen offset:1024 lds
    s_add_u32 s48, s48, 131072
    s_add_u32 s49, s49, s52
    s_add_u32 m0, s46, 73728
    s_nop 0
    buffer_load_dwordx4 v10, s[16:19], s48 offen offset:0 lds
    buffer_load_dwordx4 v11, s[16:19], s48 offen offset:1024 lds
    buffer_load_dwordx4 v12, s[16:19], s48 offen offset:2048 lds
    buffer_load_dwordx4 v13, s[16:19], s48 offen offset:3072 lds
    s_add_u32 m0, s47, 73728
    s_nop 0
    buffer_load_dwordx4 v14, s[20:23], s49 offen offset:0 lds
    buffer_load_dwordx4 v15, s[20:23], s49 offen offset:1024 lds
    s_add_u32 s48, s48, 131072
    s_add_u32 s49, s49, s52
    s_add_u32 m0, s46, 98304
    s_nop 0
    buffer_load_dwordx4 v10, s[16:19], s48 offen offset:0 lds
    buffer_load_dwordx4 v11, s[16:19], s48 offen offset:1024 lds
    buffer_load_dwordx4 v12, s[16:19], s48 offen offset:2048 lds
    buffer_load_dwordx4 v13, s[16:19], s48 offen offset:3072 lds
    s_add_u32 m0, s47, 98304
    s_nop 0
    buffer_load_dwordx4 v14, s[20:23], s49 offen offset:0 lds
    buffer_load_dwordx4 v15, s[20:23], s49 offen offset:1024 lds
    s_add_u32 s48, s48, 131072
    s_add_u32 s49, s49, s52
    s_add_u32 m0, s46, 122880
    s_nop 0
    buffer_load_dwordx4 v10, s[16:19], s48 offen offset:0 lds
    buffer_load_dwordx4 v11, s[16:19], s48 offen offset:1024 lds
    buffer_load_dwordx4 v12, s[16:19], s48 offen offset:2048 lds
    buffer_load_dwordx4 v13, s[16:19], s48 offen offset:3072 lds
    s_add_u32 m0, s47, 122880
    s_nop 0
    buffer_load_dwordx4 v14, s[20:23], s49 offen offset:0 lds
    buffer_load_dwordx4 v15, s[20:23], s49 offen offset:1024 lds
    s_add_u32 s48, s48, 131072
    s_add_u32 s49, s49, s52
    s_mov_b32 s50, 8
gemm2_kernel_lloopa:
    s_waitcnt vmcnt(24)
    s_barrier
    s_add_u32 m0, s46, 0
    s_nop 0
    buffer_load_dwordx4 v10, s[16:19], s48 offen offset:0 lds
    buffer_load_dwordx4 v11, s[16:19], s48 offen offset:1024 lds
    buffer_load_dwordx4 v12, s[16:19], s48 offen offset:2048 lds
    buffer_load_dwordx4 v13, s[16:19], s48 offen offset:3072 lds
    s_add_u32 m0, s47, 0
    s_nop 0
    buffer_load_dwordx4 v14, s[20:23], s49 offen offset:0 lds
    buffer_load_dwordx4 v15, s[20:23], s49 offen offset:1024 lds
    s_add_u32 s48, s48, 131072
    s_add_u32 s49, s49, s52
    s_waitcnt vmcnt(24)
    s_barrier
    s_add_u32 m0, s46, 24576
    s_nop 0
    buffer_load_dwordx4 v10, s[16:19], s48 offen offset:0 lds
    buffer_load_dwordx4 v11, s[16:19], s48 offen offset:1024 lds
    buffer_load_dwordx4 v12, s[16:19], s48 offen offset:2048 lds
    buffer_load_dwordx4 v13, s[16:19], s48 offen offset:3072 lds
    s_add_u32 m0, s47, 24576
    s_nop 0
    buffer_load_dwordx4 v14, s[20:23], s49 offen offset:0 lds
    buffer_load_dwordx4 v15, s[20:23], s49 offen offset:1024 lds
    s_add_u32 s48, s48, 131072
    s_add_u32 s49, s49, s52
    s_waitcnt vmcnt(24)
    s_barrier
    s_add_u32 m0, s46, 49152
    s_nop 0
    buffer_load_dwordx4 v10, s[16:19], s48 offen offset:0 lds
    buffer_load_dwordx4 v11, s[16:19], s48 offen offset:1024 lds
    buffer_load_dwordx4 v12, s[16:19], s48 offen offset:2048 lds
    buffer_load_dwordx4 v13, s[16:19], s48 offen offset:3072 lds
    s_add_u32 m0, s47, 49152
    s_nop 0
    buffer_load_dwordx4 v14, s[20:23], s49 offen offset:0 lds
    buffer_load_dwordx4 v15, s[20:23], s49 offen offset:1024 lds
    s_add_u32 s48, s48, 131072
    s_add_u32 s49, s49, s52
    s_waitcnt vmcnt(24)
    s_barrier
    s_add_u32 m0, s46, 73728
    s_nop 0
    buffer_load_dwordx4 v10, s[16:19], s48 offen offset:0 lds
    buffer_load_dwordx4 v11, s[16:19], s48 offen offset:1024 lds
    buffer_load_dwordx4 v12, s[16:19], s48 offen offset:2048 lds
    buffer_load_dwordx4 v13, s[16:19], s48 offen offset:3072 lds
    s_add_u32 m0, s47, 73728
    s_nop 0
    buffer_load_dwordx4 v14, s[20:23], s49 offen offset:0 lds
    buffer_load_dwordx4 v15, s[20:23], s49 offen offset:1024 lds
    s_add_u32 s48, s48, 131072
    s_add_u32 s49, s49, s52
    s_waitcnt vmcnt(24)
    s_barrier
    s_add_u32 m0, s46, 98304
    s_nop 0
    buffer_load_dwordx4 v10, s[16:19], s48 offen offset:0 lds
    buffer_load_dwordx4 v11, s[16:19], s48 offen offset:1024 lds
    buffer_load_dwordx4 v12, s[16:19], s48 offen offset:2048 lds
    buffer_load_dwordx4 v13, s[16:19], s48 offen offset:3072 lds
    s_add_u32 m0, s47, 98304
    s_nop 0
    buffer_load_dwordx4 v14, s[20:23], s49 offen offset:0 lds
    buffer_load_dwordx4 v15, s[20:23], s49 offen offset:1024 lds
    s_add_u32 s48, s48, 131072
    s_add_u32 s49, s49, s52
    s_waitcnt vmcnt(24)
    s_barrier
    s_add_u32 m0, s46, 122880
    s_nop 0
    buffer_load_dwordx4 v10, s[16:19], s48 offen offset:0 lds
    buffer_load_dwordx4 v11, s[16:19], s48 offen offset:1024 lds
    buffer_load_dwordx4 v12, s[16:19], s48 offen offset:2048 lds
    buffer_load_dwordx4 v13, s[16:19], s48 offen offset:3072 lds
    s_add_u32 m0, s47, 122880
    s_nop 0
    buffer_load_dwordx4 v14, s[20:23], s49 offen offset:0 lds
    buffer_load_dwordx4 v15, s[20:23], s49 offen offset:1024 lds
    s_add_u32 s48, s48, 131072
    s_add_u32 s49, s49, s52
    s_sub_u32 s50, s50, 1
    s_cmp_lg_u32 s50, 0
    s_cbranch_scc1 gemm2_kernel_lloopa

    s_waitcnt vmcnt(24)
    s_barrier
    s_add_u32 m0, s46, 0
    s_nop 0
    buffer_load_dwordx4 v10, s[16:19], s48 offen offset:0 lds
    buffer_load_dwordx4 v11, s[16:19], s48 offen offset:1024 lds
    buffer_load_dwordx4 v12, s[16:19], s48 offen offset:2048 lds
    buffer_load_dwordx4 v13, s[16:19], s48 offen offset:3072 lds
    s_add_u32 m0, s47, 0
    s_nop 0
    buffer_load_dwordx4 v14, s[20:23], s49 offen offset:0 lds
    buffer_load_dwordx4 v15, s[20:23], s49 offen offset:1024 lds
    s_add_u32 s48, s48, 131072
    s_add_u32 s49, s49, s52
    s_waitcnt vmcnt(24)
    s_barrier
    s_add_u32 m0, s46, 24576
    s_nop 0
    buffer_load_dwordx4 v10, s[16:19], s48 offen offset:0 lds
    buffer_load_dwordx4 v11, s[16:19], s48 offen offset:1024 lds
    buffer_load_dwordx4 v12, s[16:19], s48 offen offset:2048 lds
    buffer_load_dwordx4 v13, s[16:19], s48 offen offset:3072 lds
    s_add_u32 m0, s47, 24576
    s_nop 0
    buffer_load_dwordx4 v14, s[20:23], s49 offen offset:0 lds
    buffer_load_dwordx4 v15, s[20:23], s49 offen offset:1024 lds
    s_add_u32 s48, s48, 131072
    s_add_u32 s49, s49, s52
    s_waitcnt vmcnt(24)
    s_barrier
    s_waitcnt vmcnt(18)
    s_barrier
    s_waitcnt vmcnt(12)
    s_barrier
    s_waitcnt vmcnt(6)
    s_barrier
    s_waitcnt vmcnt(0)
    s_barrier
    s_load_dwordx2 s[12:13], s[0:1], 0
    s_load_dwordx2 s[14:15], s[0:1], 88
    s_and_b32 s38, s32, 1
    s_lshr_b32 s39, s32, 1
    s_waitcnt lgkmcnt(0)

    s_mov_b32 s24, s10
    s_mov_b32 s25, s11
    s_and_b32 s25, s25, 0xffff
    s_mov_b32 s26, 0x1000
    s_mov_b32 s27, 0x20000
    s_mov_b32 s28, s12
    s_mov_b32 s29, s13
    s_and_b32 s29, s29, 0xffff
    s_mov_b32 s30, 0x400000
    s_mov_b32 s31, 0x20000
    s_add_u32 s52, s4, 0x1400000
    s_addc_u32 s53, s5, 0
    s_and_b32 s53, s53, 0xffff
    s_mov_b32 s54, 0x4000
    s_mov_b32 s55, 0x20000
    s_add_u32 s56, s4, 0x800000
    s_addc_u32 s57, s5, 0
    s_and_b32 s57, s57, 0xffff
    s_mov_b32 s58, 0x400000
    s_mov_b32 s59, 0x20000
    s_mov_b32 s60, s14
    s_mov_b32 s61, s15
    s_and_b32 s61, s61, 0xffff
    s_mov_b32 s62, 0x400000
    s_mov_b32 s63, 0x20000
    s_lshl_b32 s43, s39, 5
    s_add_u32 s43, s43, s36
    v_add_u32 v4, s43, v3
    v_lshlrev_b32 v12, 1, v4
    v_lshlrev_b32 v13, 3, v4
    s_lshl_b32 s44, s38, 6
    s_add_u32 s44, s44, s35
    v_lshl_add_u32 v6, v2, 2, s44
    v_lshlrev_b32 v7, 1, v6
    v_lshl_add_u32 v8, v4, 11, v7
    v_lshl_add_u32 v1, v6, 12, v12
    v_add_u32 v9, 32768, v8

    buffer_load_ushort v11, v12, s[24:27], 0 offen offset:32
    buffer_load_dwordx2 v[6:7], v13, s[52:55], 0 offen offset:128
    buffer_load_dwordx2 v[120:121], v9, s[28:31], 0 offen offset:0
    s_mov_b32 s45, 0
    buffer_load_ushort v144, v1, s[56:59], s45 offen offset:32
    s_mov_b32 s45, 4096
    buffer_load_ushort v145, v1, s[56:59], s45 offen offset:32
    s_mov_b32 s45, 8192
    buffer_load_ushort v146, v1, s[56:59], s45 offen offset:32
    s_mov_b32 s45, 12288
    buffer_load_ushort v147, v1, s[56:59], s45 offen offset:32
    buffer_load_dwordx2 v[122:123], v9, s[28:31], 0 offen offset:32
    s_mov_b32 s45, 65536
    buffer_load_ushort v148, v1, s[56:59], s45 offen offset:32
    s_mov_b32 s45, 69632
    buffer_load_ushort v149, v1, s[56:59], s45 offen offset:32
    s_mov_b32 s45, 73728
    buffer_load_ushort v150, v1, s[56:59], s45 offen offset:32
    s_mov_b32 s45, 77824
    buffer_load_ushort v151, v1, s[56:59], s45 offen offset:32
    buffer_load_dwordx2 v[124:125], v9, s[28:31], 0 offen offset:64
    s_mov_b32 s45, 131072
    buffer_load_ushort v152, v1, s[56:59], s45 offen offset:32
    s_mov_b32 s45, 135168
    buffer_load_ushort v153, v1, s[56:59], s45 offen offset:32
    s_mov_b32 s45, 139264
    buffer_load_ushort v154, v1, s[56:59], s45 offen offset:32
    s_mov_b32 s45, 143360
    buffer_load_ushort v155, v1, s[56:59], s45 offen offset:32
    buffer_load_dwordx2 v[126:127], v9, s[28:31], 0 offen offset:96
    s_mov_b32 s45, 196608
    buffer_load_ushort v156, v1, s[56:59], s45 offen offset:32
    s_mov_b32 s45, 200704
    buffer_load_ushort v157, v1, s[56:59], s45 offen offset:32
    s_mov_b32 s45, 204800
    buffer_load_ushort v158, v1, s[56:59], s45 offen offset:32
    s_mov_b32 s45, 208896
    buffer_load_ushort v159, v1, s[56:59], s45 offen offset:32
    s_mul_i32 s43, s32, 4096
    s_add_u32 s43, s43, 0
    v_lshlrev_b32 v15, 4, v0
    v_add_u32 v15, s43, v15
    s_barrier

    ds_read_b128 v[48:51], v15 offset:0
    ds_read_b128 v[52:55], v15 offset:1024
    ds_read_b128 v[56:59], v15 offset:2048
    ds_read_b128 v[60:63], v15 offset:3072
    s_waitcnt lgkmcnt(0)
    v_mov_b32 v1, 0xffff0000
    s_waitcnt vmcnt(0)

    v_lshlrev_b32 v78, 16, v11
    v_lshlrev_b32 v79, 16, v11
    v_rcp_f32 v86, v7
    v_rcp_f32 v87, v7
    v_mov_b32 v84, v6
    v_mov_b32 v85, v6
    s_nop 0
    v_cvt_pk_bf16_f32 v64, v48, v49
    v_cvt_pk_bf16_f32 v65, v50, v51
    v_lshlrev_b32 v48, 16, v64
    v_lshlrev_b32 v50, 16, v65
    v_and_b32 v49, v1, v64
    v_and_b32 v51, v1, v65
    v_pk_add_f32 v[48:49], v[48:49], v[78:79]
    v_pk_add_f32 v[50:51], v[50:51], v[78:79]
    v_cvt_pk_bf16_f32 v64, v48, v49
    v_cvt_pk_bf16_f32 v65, v50, v51
    v_lshlrev_b32 v48, 16, v64
    v_lshlrev_b32 v50, 16, v65
    v_and_b32 v49, v1, v64
    v_and_b32 v51, v1, v65
    v_lshlrev_b32 v66, 16, v120
    v_lshlrev_b32 v68, 16, v121
    v_and_b32 v67, v1, v120
    v_and_b32 v69, v1, v121
    v_pk_add_f32 v[14:15], v[66:67], v[84:85] neg_lo:[0,1] neg_hi:[0,1]
    v_pk_add_f32 v[16:17], v[68:69], v[84:85] neg_lo:[0,1] neg_hi:[0,1]
    v_cvt_pk_bf16_f32 v64, v14, v15
    v_cvt_pk_bf16_f32 v65, v16, v17
    v_lshlrev_b32 v14, 16, v64
    v_lshlrev_b32 v16, 16, v65
    v_and_b32 v15, v1, v64
    v_and_b32 v17, v1, v65
    v_pk_mul_f32 v[14:15], v[14:15], v[86:87]
    v_pk_mul_f32 v[16:17], v[16:17], v[86:87]
    v_cvt_pk_bf16_f32 v64, v14, v15
    v_cvt_pk_bf16_f32 v65, v16, v17
    v_lshlrev_b32 v14, 16, v64
    v_lshlrev_b32 v16, 16, v65
    v_and_b32 v15, v1, v64
    v_and_b32 v17, v1, v65
    v_lshlrev_b32 v144, 16, v144
    v_lshlrev_b32 v146, 16, v146
    v_lshlrev_b32 v145, 16, v145
    v_lshlrev_b32 v147, 16, v147
    v_pk_mul_f32 v[14:15], v[14:15], v[144:145]
    v_pk_mul_f32 v[16:17], v[16:17], v[146:147]
    v_cvt_pk_bf16_f32 v64, v14, v15
    v_cvt_pk_bf16_f32 v65, v16, v17
    v_lshlrev_b32 v14, 16, v64
    v_lshlrev_b32 v16, 16, v65
    v_and_b32 v15, v1, v64
    v_and_b32 v17, v1, v65
    v_pk_add_f32 v[14:15], v[66:67], v[14:15]
    v_pk_add_f32 v[16:17], v[68:69], v[16:17]
    v_cvt_pk_bf16_f32 v64, v14, v15
    v_cvt_pk_bf16_f32 v65, v16, v17
    v_lshlrev_b32 v14, 16, v64
    v_lshlrev_b32 v16, 16, v65
    v_and_b32 v15, v1, v64
    v_and_b32 v17, v1, v65
    v_pk_add_f32 v[14:15], v[14:15], v[48:49]
    v_pk_add_f32 v[16:17], v[16:17], v[50:51]
    v_cvt_pk_bf16_f32 v72, v14, v15
    v_cvt_pk_bf16_f32 v73, v16, v17
    buffer_store_dwordx2 v[72:73], v9, s[60:63], 0 offen offset:0
    v_cvt_pk_bf16_f32 v64, v52, v53
    v_cvt_pk_bf16_f32 v65, v54, v55
    v_lshlrev_b32 v52, 16, v64
    v_lshlrev_b32 v54, 16, v65
    v_and_b32 v53, v1, v64
    v_and_b32 v55, v1, v65
    v_pk_add_f32 v[52:53], v[52:53], v[78:79]
    v_pk_add_f32 v[54:55], v[54:55], v[78:79]
    v_cvt_pk_bf16_f32 v64, v52, v53
    v_cvt_pk_bf16_f32 v65, v54, v55
    v_lshlrev_b32 v52, 16, v64
    v_lshlrev_b32 v54, 16, v65
    v_and_b32 v53, v1, v64
    v_and_b32 v55, v1, v65
    v_lshlrev_b32 v66, 16, v122
    v_lshlrev_b32 v68, 16, v123
    v_and_b32 v67, v1, v122
    v_and_b32 v69, v1, v123
    v_pk_add_f32 v[14:15], v[66:67], v[84:85] neg_lo:[0,1] neg_hi:[0,1]
    v_pk_add_f32 v[16:17], v[68:69], v[84:85] neg_lo:[0,1] neg_hi:[0,1]
    v_cvt_pk_bf16_f32 v64, v14, v15
    v_cvt_pk_bf16_f32 v65, v16, v17
    v_lshlrev_b32 v14, 16, v64
    v_lshlrev_b32 v16, 16, v65
    v_and_b32 v15, v1, v64
    v_and_b32 v17, v1, v65
    v_pk_mul_f32 v[14:15], v[14:15], v[86:87]
    v_pk_mul_f32 v[16:17], v[16:17], v[86:87]
    v_cvt_pk_bf16_f32 v64, v14, v15
    v_cvt_pk_bf16_f32 v65, v16, v17
    v_lshlrev_b32 v14, 16, v64
    v_lshlrev_b32 v16, 16, v65
    v_and_b32 v15, v1, v64
    v_and_b32 v17, v1, v65
    v_lshlrev_b32 v148, 16, v148
    v_lshlrev_b32 v150, 16, v150
    v_lshlrev_b32 v149, 16, v149
    v_lshlrev_b32 v151, 16, v151
    v_pk_mul_f32 v[14:15], v[14:15], v[148:149]
    v_pk_mul_f32 v[16:17], v[16:17], v[150:151]
    v_cvt_pk_bf16_f32 v64, v14, v15
    v_cvt_pk_bf16_f32 v65, v16, v17
    v_lshlrev_b32 v14, 16, v64
    v_lshlrev_b32 v16, 16, v65
    v_and_b32 v15, v1, v64
    v_and_b32 v17, v1, v65
    v_pk_add_f32 v[14:15], v[66:67], v[14:15]
    v_pk_add_f32 v[16:17], v[68:69], v[16:17]
    v_cvt_pk_bf16_f32 v64, v14, v15
    v_cvt_pk_bf16_f32 v65, v16, v17
    v_lshlrev_b32 v14, 16, v64
    v_lshlrev_b32 v16, 16, v65
    v_and_b32 v15, v1, v64
    v_and_b32 v17, v1, v65
    v_pk_add_f32 v[14:15], v[14:15], v[52:53]
    v_pk_add_f32 v[16:17], v[16:17], v[54:55]
    v_cvt_pk_bf16_f32 v74, v14, v15
    v_cvt_pk_bf16_f32 v75, v16, v17
    buffer_store_dwordx2 v[74:75], v9, s[60:63], 0 offen offset:32
    v_cvt_pk_bf16_f32 v64, v56, v57
    v_cvt_pk_bf16_f32 v65, v58, v59
    v_lshlrev_b32 v56, 16, v64
    v_lshlrev_b32 v58, 16, v65
    v_and_b32 v57, v1, v64
    v_and_b32 v59, v1, v65
    v_pk_add_f32 v[56:57], v[56:57], v[78:79]
    v_pk_add_f32 v[58:59], v[58:59], v[78:79]
    v_cvt_pk_bf16_f32 v64, v56, v57
    v_cvt_pk_bf16_f32 v65, v58, v59
    v_lshlrev_b32 v56, 16, v64
    v_lshlrev_b32 v58, 16, v65
    v_and_b32 v57, v1, v64
    v_and_b32 v59, v1, v65
    v_lshlrev_b32 v66, 16, v124
    v_lshlrev_b32 v68, 16, v125
    v_and_b32 v67, v1, v124
    v_and_b32 v69, v1, v125
    v_pk_add_f32 v[14:15], v[66:67], v[84:85] neg_lo:[0,1] neg_hi:[0,1]
    v_pk_add_f32 v[16:17], v[68:69], v[84:85] neg_lo:[0,1] neg_hi:[0,1]
    v_cvt_pk_bf16_f32 v64, v14, v15
    v_cvt_pk_bf16_f32 v65, v16, v17
    v_lshlrev_b32 v14, 16, v64
    v_lshlrev_b32 v16, 16, v65
    v_and_b32 v15, v1, v64
    v_and_b32 v17, v1, v65
    v_pk_mul_f32 v[14:15], v[14:15], v[86:87]
    v_pk_mul_f32 v[16:17], v[16:17], v[86:87]
    v_cvt_pk_bf16_f32 v64, v14, v15
    v_cvt_pk_bf16_f32 v65, v16, v17
    v_lshlrev_b32 v14, 16, v64
    v_lshlrev_b32 v16, 16, v65
    v_and_b32 v15, v1, v64
    v_and_b32 v17, v1, v65
    v_lshlrev_b32 v152, 16, v152
    v_lshlrev_b32 v154, 16, v154
    v_lshlrev_b32 v153, 16, v153
    v_lshlrev_b32 v155, 16, v155
    v_pk_mul_f32 v[14:15], v[14:15], v[152:153]
    v_pk_mul_f32 v[16:17], v[16:17], v[154:155]
    v_cvt_pk_bf16_f32 v64, v14, v15
    v_cvt_pk_bf16_f32 v65, v16, v17
    v_lshlrev_b32 v14, 16, v64
    v_lshlrev_b32 v16, 16, v65
    v_and_b32 v15, v1, v64
    v_and_b32 v17, v1, v65
    v_pk_add_f32 v[14:15], v[66:67], v[14:15]
    v_pk_add_f32 v[16:17], v[68:69], v[16:17]
    v_cvt_pk_bf16_f32 v64, v14, v15
    v_cvt_pk_bf16_f32 v65, v16, v17
    v_lshlrev_b32 v14, 16, v64
    v_lshlrev_b32 v16, 16, v65
    v_and_b32 v15, v1, v64
    v_and_b32 v17, v1, v65
    v_pk_add_f32 v[14:15], v[14:15], v[56:57]
    v_pk_add_f32 v[16:17], v[16:17], v[58:59]
    v_cvt_pk_bf16_f32 v72, v14, v15
    v_cvt_pk_bf16_f32 v73, v16, v17
    buffer_store_dwordx2 v[72:73], v9, s[60:63], 0 offen offset:64
    v_cvt_pk_bf16_f32 v64, v60, v61
    v_cvt_pk_bf16_f32 v65, v62, v63
    v_lshlrev_b32 v60, 16, v64
    v_lshlrev_b32 v62, 16, v65
    v_and_b32 v61, v1, v64
    v_and_b32 v63, v1, v65
    v_pk_add_f32 v[60:61], v[60:61], v[78:79]
    v_pk_add_f32 v[62:63], v[62:63], v[78:79]
    v_cvt_pk_bf16_f32 v64, v60, v61
    v_cvt_pk_bf16_f32 v65, v62, v63
    v_lshlrev_b32 v60, 16, v64
    v_lshlrev_b32 v62, 16, v65
    v_and_b32 v61, v1, v64
    v_and_b32 v63, v1, v65
    v_lshlrev_b32 v66, 16, v126
    v_lshlrev_b32 v68, 16, v127
    v_and_b32 v67, v1, v126
    v_and_b32 v69, v1, v127
    v_pk_add_f32 v[14:15], v[66:67], v[84:85] neg_lo:[0,1] neg_hi:[0,1]
    v_pk_add_f32 v[16:17], v[68:69], v[84:85] neg_lo:[0,1] neg_hi:[0,1]
    v_cvt_pk_bf16_f32 v64, v14, v15
    v_cvt_pk_bf16_f32 v65, v16, v17
    v_lshlrev_b32 v14, 16, v64
    v_lshlrev_b32 v16, 16, v65
    v_and_b32 v15, v1, v64
    v_and_b32 v17, v1, v65
    v_pk_mul_f32 v[14:15], v[14:15], v[86:87]
    v_pk_mul_f32 v[16:17], v[16:17], v[86:87]
    v_cvt_pk_bf16_f32 v64, v14, v15
    v_cvt_pk_bf16_f32 v65, v16, v17
    v_lshlrev_b32 v14, 16, v64
    v_lshlrev_b32 v16, 16, v65
    v_and_b32 v15, v1, v64
    v_and_b32 v17, v1, v65
    v_lshlrev_b32 v156, 16, v156
    v_lshlrev_b32 v158, 16, v158
    v_lshlrev_b32 v157, 16, v157
    v_lshlrev_b32 v159, 16, v159
    v_pk_mul_f32 v[14:15], v[14:15], v[156:157]
    v_pk_mul_f32 v[16:17], v[16:17], v[158:159]
    v_cvt_pk_bf16_f32 v64, v14, v15
    v_cvt_pk_bf16_f32 v65, v16, v17
    v_lshlrev_b32 v14, 16, v64
    v_lshlrev_b32 v16, 16, v65
    v_and_b32 v15, v1, v64
    v_and_b32 v17, v1, v65
    v_pk_add_f32 v[14:15], v[66:67], v[14:15]
    v_pk_add_f32 v[16:17], v[68:69], v[16:17]
    v_cvt_pk_bf16_f32 v64, v14, v15
    v_cvt_pk_bf16_f32 v65, v16, v17
    v_lshlrev_b32 v14, 16, v64
    v_lshlrev_b32 v16, 16, v65
    v_and_b32 v15, v1, v64
    v_and_b32 v17, v1, v65
    v_pk_add_f32 v[14:15], v[14:15], v[60:61]
    v_pk_add_f32 v[16:17], v[16:17], v[62:63]
    v_cvt_pk_bf16_f32 v74, v14, v15
    v_cvt_pk_bf16_f32 v75, v16, v17
    buffer_store_dwordx2 v[74:75], v9, s[60:63], 0 offen offset:96
    s_endpgm
gemm2_kernel_compute:
    s_and_b32 s38, s32, 1
    s_lshr_b32 s39, s32, 1
    s_lshl_b32 s43, s38, 2

    v_bfe_u32 v4, v0, 2, 2
    v_lshl_add_u32 v4, v2, 2, v4
    v_and_b32 v5, 3, v0
    v_lshlrev_b32 v5, 3, v5
    v_lshl_add_u32 v6, v4, 8, v5
    v_and_b32 v7, 7, v4

    s_add_u32 s44, s43, 0
    v_xor_b32 v8, s44, v7
    v_lshl_add_u32 v16, v8, 5, v6
    v_add_u32 v20, 49152, v16

    v_add_u32 v26, 98304, v16
    s_add_u32 s44, s43, 1
    v_xor_b32 v8, s44, v7
    v_lshl_add_u32 v17, v8, 5, v6
    v_add_u32 v21, 49152, v17

    v_add_u32 v27, 98304, v17
    s_add_u32 s44, s43, 2
    v_xor_b32 v8, s44, v7
    v_lshl_add_u32 v18, v8, 5, v6
    v_add_u32 v22, 49152, v18

    v_add_u32 v30, 98304, v18
    s_add_u32 s44, s43, 3
    v_xor_b32 v8, s44, v7
    v_lshl_add_u32 v19, v8, 5, v6
    v_add_u32 v23, 49152, v19

    v_add_u32 v31, 98304, v19
    v_lshl_add_u32 v6, v4, 7, v5
    v_bfe_u32 v7, v4, 1, 2
    s_lshl_b32 s43, s39, 1

    s_add_u32 s44, s43, 0
    v_xor_b32 v8, s44, v7
    v_lshl_add_u32 v24, v8, 5, v6
    v_add_u32 v28, 49152, v24
    v_add_u32 v14, 98304, v24

    s_add_u32 s44, s43, 1
    v_xor_b32 v8, s44, v7
    v_lshl_add_u32 v25, v8, 5, v6
    v_add_u32 v29, 49152, v25
    v_add_u32 v15, 98304, v25

    v_mov_b32 v32, 0
    v_mov_b32 v33, 0
    v_mov_b32 v34, 0
    v_mov_b32 v35, 0
    v_mov_b32 v36, 0
    v_mov_b32 v37, 0
    v_mov_b32 v38, 0
    v_mov_b32 v39, 0
    v_mov_b32 v40, 0
    v_mov_b32 v41, 0
    v_mov_b32 v42, 0
    v_mov_b32 v43, 0
    v_mov_b32 v44, 0
    v_mov_b32 v45, 0
    v_mov_b32 v46, 0
    v_mov_b32 v47, 0
    v_mov_b32 v48, 0
    v_mov_b32 v49, 0
    v_mov_b32 v50, 0
    v_mov_b32 v51, 0
    v_mov_b32 v52, 0
    v_mov_b32 v53, 0
    v_mov_b32 v54, 0
    v_mov_b32 v55, 0
    v_mov_b32 v56, 0
    v_mov_b32 v57, 0
    v_mov_b32 v58, 0
    v_mov_b32 v59, 0
    v_mov_b32 v60, 0
    v_mov_b32 v61, 0
    v_mov_b32 v62, 0
    v_mov_b32 v63, 0
    s_load_dwordx2 s[12:13], s[0:1], 0
    s_load_dwordx2 s[14:15], s[0:1], 88
    s_waitcnt lgkmcnt(0)

    s_barrier
    ds_read_b64_tr_b16 v[64:65], v16 offset:0
    ds_read_b64_tr_b16 v[66:67], v16 offset:4096
    ds_read_b64_tr_b16 v[68:69], v17 offset:0
    ds_read_b64_tr_b16 v[70:71], v17 offset:4096
    ds_read_b64_tr_b16 v[72:73], v18 offset:0
    ds_read_b64_tr_b16 v[74:75], v18 offset:4096
    ds_read_b64_tr_b16 v[76:77], v19 offset:0
    ds_read_b64_tr_b16 v[78:79], v19 offset:4096
    ds_read_b64_tr_b16 v[80:81], v24 offset:16384
    ds_read_b64_tr_b16 v[82:83], v24 offset:18432
    ds_read_b64_tr_b16 v[84:85], v25 offset:16384
    ds_read_b64_tr_b16 v[86:87], v25 offset:18432
    s_mov_b32 s50, 8
gemm2_kernel_loop:
    s_waitcnt lgkmcnt(0)
    v_mfma_f32_16x16x32_bf16 v[32:35], v[64:67], v[80:83], v[32:35]
    ds_read_b64_tr_b16 v[88:89], v16 offset:8192
    ds_read_b64_tr_b16 v[90:91], v16 offset:12288
    v_mfma_f32_16x16x32_bf16 v[36:39], v[68:71], v[80:83], v[36:39]
    ds_read_b64_tr_b16 v[92:93], v17 offset:8192
    ds_read_b64_tr_b16 v[94:95], v17 offset:12288
    v_mfma_f32_16x16x32_bf16 v[40:43], v[72:75], v[80:83], v[40:43]
    ds_read_b64_tr_b16 v[96:97], v18 offset:8192
    ds_read_b64_tr_b16 v[98:99], v18 offset:12288
    v_mfma_f32_16x16x32_bf16 v[44:47], v[76:79], v[80:83], v[44:47]
    ds_read_b64_tr_b16 v[100:101], v19 offset:8192
    ds_read_b64_tr_b16 v[102:103], v19 offset:12288
    v_mfma_f32_16x16x32_bf16 v[48:51], v[64:67], v[84:87], v[48:51]
    ds_read_b64_tr_b16 v[104:105], v24 offset:20480
    ds_read_b64_tr_b16 v[106:107], v24 offset:22528
    v_mfma_f32_16x16x32_bf16 v[52:55], v[68:71], v[84:87], v[52:55]
    ds_read_b64_tr_b16 v[108:109], v25 offset:20480
    ds_read_b64_tr_b16 v[110:111], v25 offset:22528
    v_mfma_f32_16x16x32_bf16 v[56:59], v[72:75], v[84:87], v[56:59]
    v_mfma_f32_16x16x32_bf16 v[60:63], v[76:79], v[84:87], v[60:63]
    s_waitcnt lgkmcnt(0)
    s_barrier
    v_mfma_f32_16x16x32_bf16 v[32:35], v[88:91], v[104:107], v[32:35]
    ds_read_b64_tr_b16 v[64:65], v16 offset:24576
    ds_read_b64_tr_b16 v[66:67], v16 offset:28672
    v_mfma_f32_16x16x32_bf16 v[36:39], v[92:95], v[104:107], v[36:39]
    ds_read_b64_tr_b16 v[68:69], v17 offset:24576
    ds_read_b64_tr_b16 v[70:71], v17 offset:28672
    v_mfma_f32_16x16x32_bf16 v[40:43], v[96:99], v[104:107], v[40:43]
    ds_read_b64_tr_b16 v[72:73], v18 offset:24576
    ds_read_b64_tr_b16 v[74:75], v18 offset:28672
    v_mfma_f32_16x16x32_bf16 v[44:47], v[100:103], v[104:107], v[44:47]
    ds_read_b64_tr_b16 v[76:77], v19 offset:24576
    ds_read_b64_tr_b16 v[78:79], v19 offset:28672
    v_mfma_f32_16x16x32_bf16 v[48:51], v[88:91], v[108:111], v[48:51]
    ds_read_b64_tr_b16 v[80:81], v24 offset:40960
    ds_read_b64_tr_b16 v[82:83], v24 offset:43008
    v_mfma_f32_16x16x32_bf16 v[52:55], v[92:95], v[108:111], v[52:55]
    ds_read_b64_tr_b16 v[84:85], v25 offset:40960
    ds_read_b64_tr_b16 v[86:87], v25 offset:43008
    v_mfma_f32_16x16x32_bf16 v[56:59], v[96:99], v[108:111], v[56:59]
    v_mfma_f32_16x16x32_bf16 v[60:63], v[100:103], v[108:111], v[60:63]
    s_waitcnt lgkmcnt(0)
    v_mfma_f32_16x16x32_bf16 v[32:35], v[64:67], v[80:83], v[32:35]
    ds_read_b64_tr_b16 v[88:89], v16 offset:32768
    ds_read_b64_tr_b16 v[90:91], v16 offset:36864
    v_mfma_f32_16x16x32_bf16 v[36:39], v[68:71], v[80:83], v[36:39]
    ds_read_b64_tr_b16 v[92:93], v17 offset:32768
    ds_read_b64_tr_b16 v[94:95], v17 offset:36864
    v_mfma_f32_16x16x32_bf16 v[40:43], v[72:75], v[80:83], v[40:43]
    ds_read_b64_tr_b16 v[96:97], v18 offset:32768
    ds_read_b64_tr_b16 v[98:99], v18 offset:36864
    v_mfma_f32_16x16x32_bf16 v[44:47], v[76:79], v[80:83], v[44:47]
    ds_read_b64_tr_b16 v[100:101], v19 offset:32768
    ds_read_b64_tr_b16 v[102:103], v19 offset:36864
    v_mfma_f32_16x16x32_bf16 v[48:51], v[64:67], v[84:87], v[48:51]
    ds_read_b64_tr_b16 v[104:105], v24 offset:45056
    ds_read_b64_tr_b16 v[106:107], v24 offset:47104
    v_mfma_f32_16x16x32_bf16 v[52:55], v[68:71], v[84:87], v[52:55]
    ds_read_b64_tr_b16 v[108:109], v25 offset:45056
    ds_read_b64_tr_b16 v[110:111], v25 offset:47104
    v_mfma_f32_16x16x32_bf16 v[56:59], v[72:75], v[84:87], v[56:59]
    v_mfma_f32_16x16x32_bf16 v[60:63], v[76:79], v[84:87], v[60:63]
    s_waitcnt lgkmcnt(0)
    s_barrier
    v_mfma_f32_16x16x32_bf16 v[32:35], v[88:91], v[104:107], v[32:35]
    ds_read_b64_tr_b16 v[64:65], v20 offset:0
    ds_read_b64_tr_b16 v[66:67], v20 offset:4096
    v_mfma_f32_16x16x32_bf16 v[36:39], v[92:95], v[104:107], v[36:39]
    ds_read_b64_tr_b16 v[68:69], v21 offset:0
    ds_read_b64_tr_b16 v[70:71], v21 offset:4096
    v_mfma_f32_16x16x32_bf16 v[40:43], v[96:99], v[104:107], v[40:43]
    ds_read_b64_tr_b16 v[72:73], v22 offset:0
    ds_read_b64_tr_b16 v[74:75], v22 offset:4096
    v_mfma_f32_16x16x32_bf16 v[44:47], v[100:103], v[104:107], v[44:47]
    ds_read_b64_tr_b16 v[76:77], v23 offset:0
    ds_read_b64_tr_b16 v[78:79], v23 offset:4096
    v_mfma_f32_16x16x32_bf16 v[48:51], v[88:91], v[108:111], v[48:51]
    ds_read_b64_tr_b16 v[80:81], v28 offset:16384
    ds_read_b64_tr_b16 v[82:83], v28 offset:18432
    v_mfma_f32_16x16x32_bf16 v[52:55], v[92:95], v[108:111], v[52:55]
    ds_read_b64_tr_b16 v[84:85], v29 offset:16384
    ds_read_b64_tr_b16 v[86:87], v29 offset:18432
    v_mfma_f32_16x16x32_bf16 v[56:59], v[96:99], v[108:111], v[56:59]
    v_mfma_f32_16x16x32_bf16 v[60:63], v[100:103], v[108:111], v[60:63]
    s_waitcnt lgkmcnt(0)
    v_mfma_f32_16x16x32_bf16 v[32:35], v[64:67], v[80:83], v[32:35]
    ds_read_b64_tr_b16 v[88:89], v20 offset:8192
    ds_read_b64_tr_b16 v[90:91], v20 offset:12288
    v_mfma_f32_16x16x32_bf16 v[36:39], v[68:71], v[80:83], v[36:39]
    ds_read_b64_tr_b16 v[92:93], v21 offset:8192
    ds_read_b64_tr_b16 v[94:95], v21 offset:12288
    v_mfma_f32_16x16x32_bf16 v[40:43], v[72:75], v[80:83], v[40:43]
    ds_read_b64_tr_b16 v[96:97], v22 offset:8192
    ds_read_b64_tr_b16 v[98:99], v22 offset:12288
    v_mfma_f32_16x16x32_bf16 v[44:47], v[76:79], v[80:83], v[44:47]
    ds_read_b64_tr_b16 v[100:101], v23 offset:8192
    ds_read_b64_tr_b16 v[102:103], v23 offset:12288
    v_mfma_f32_16x16x32_bf16 v[48:51], v[64:67], v[84:87], v[48:51]
    ds_read_b64_tr_b16 v[104:105], v28 offset:20480
    ds_read_b64_tr_b16 v[106:107], v28 offset:22528
    v_mfma_f32_16x16x32_bf16 v[52:55], v[68:71], v[84:87], v[52:55]
    ds_read_b64_tr_b16 v[108:109], v29 offset:20480
    ds_read_b64_tr_b16 v[110:111], v29 offset:22528
    v_mfma_f32_16x16x32_bf16 v[56:59], v[72:75], v[84:87], v[56:59]
    v_mfma_f32_16x16x32_bf16 v[60:63], v[76:79], v[84:87], v[60:63]
    s_waitcnt lgkmcnt(0)
    s_barrier
    v_mfma_f32_16x16x32_bf16 v[32:35], v[88:91], v[104:107], v[32:35]
    ds_read_b64_tr_b16 v[64:65], v20 offset:24576
    ds_read_b64_tr_b16 v[66:67], v20 offset:28672
    v_mfma_f32_16x16x32_bf16 v[36:39], v[92:95], v[104:107], v[36:39]
    ds_read_b64_tr_b16 v[68:69], v21 offset:24576
    ds_read_b64_tr_b16 v[70:71], v21 offset:28672
    v_mfma_f32_16x16x32_bf16 v[40:43], v[96:99], v[104:107], v[40:43]
    ds_read_b64_tr_b16 v[72:73], v22 offset:24576
    ds_read_b64_tr_b16 v[74:75], v22 offset:28672
    v_mfma_f32_16x16x32_bf16 v[44:47], v[100:103], v[104:107], v[44:47]
    ds_read_b64_tr_b16 v[76:77], v23 offset:24576
    ds_read_b64_tr_b16 v[78:79], v23 offset:28672
    v_mfma_f32_16x16x32_bf16 v[48:51], v[88:91], v[108:111], v[48:51]
    ds_read_b64_tr_b16 v[80:81], v28 offset:40960
    ds_read_b64_tr_b16 v[82:83], v28 offset:43008
    v_mfma_f32_16x16x32_bf16 v[52:55], v[92:95], v[108:111], v[52:55]
    ds_read_b64_tr_b16 v[84:85], v29 offset:40960
    ds_read_b64_tr_b16 v[86:87], v29 offset:43008
    v_mfma_f32_16x16x32_bf16 v[56:59], v[96:99], v[108:111], v[56:59]
    v_mfma_f32_16x16x32_bf16 v[60:63], v[100:103], v[108:111], v[60:63]
    s_waitcnt lgkmcnt(0)
    v_mfma_f32_16x16x32_bf16 v[32:35], v[64:67], v[80:83], v[32:35]
    ds_read_b64_tr_b16 v[88:89], v20 offset:32768
    ds_read_b64_tr_b16 v[90:91], v20 offset:36864
    v_mfma_f32_16x16x32_bf16 v[36:39], v[68:71], v[80:83], v[36:39]
    ds_read_b64_tr_b16 v[92:93], v21 offset:32768
    ds_read_b64_tr_b16 v[94:95], v21 offset:36864
    v_mfma_f32_16x16x32_bf16 v[40:43], v[72:75], v[80:83], v[40:43]
    ds_read_b64_tr_b16 v[96:97], v22 offset:32768
    ds_read_b64_tr_b16 v[98:99], v22 offset:36864
    v_mfma_f32_16x16x32_bf16 v[44:47], v[76:79], v[80:83], v[44:47]
    ds_read_b64_tr_b16 v[100:101], v23 offset:32768
    ds_read_b64_tr_b16 v[102:103], v23 offset:36864
    v_mfma_f32_16x16x32_bf16 v[48:51], v[64:67], v[84:87], v[48:51]
    ds_read_b64_tr_b16 v[104:105], v28 offset:45056
    ds_read_b64_tr_b16 v[106:107], v28 offset:47104
    v_mfma_f32_16x16x32_bf16 v[52:55], v[68:71], v[84:87], v[52:55]
    ds_read_b64_tr_b16 v[108:109], v29 offset:45056
    ds_read_b64_tr_b16 v[110:111], v29 offset:47104
    v_mfma_f32_16x16x32_bf16 v[56:59], v[72:75], v[84:87], v[56:59]
    v_mfma_f32_16x16x32_bf16 v[60:63], v[76:79], v[84:87], v[60:63]
    s_waitcnt lgkmcnt(0)
    s_barrier
    v_mfma_f32_16x16x32_bf16 v[32:35], v[88:91], v[104:107], v[32:35]
    ds_read_b64_tr_b16 v[64:65], v26 offset:0
    ds_read_b64_tr_b16 v[66:67], v26 offset:4096
    v_mfma_f32_16x16x32_bf16 v[36:39], v[92:95], v[104:107], v[36:39]
    ds_read_b64_tr_b16 v[68:69], v27 offset:0
    ds_read_b64_tr_b16 v[70:71], v27 offset:4096
    v_mfma_f32_16x16x32_bf16 v[40:43], v[96:99], v[104:107], v[40:43]
    ds_read_b64_tr_b16 v[72:73], v30 offset:0
    ds_read_b64_tr_b16 v[74:75], v30 offset:4096
    v_mfma_f32_16x16x32_bf16 v[44:47], v[100:103], v[104:107], v[44:47]
    ds_read_b64_tr_b16 v[76:77], v31 offset:0
    ds_read_b64_tr_b16 v[78:79], v31 offset:4096
    v_mfma_f32_16x16x32_bf16 v[48:51], v[88:91], v[108:111], v[48:51]
    ds_read_b64_tr_b16 v[80:81], v14 offset:16384
    ds_read_b64_tr_b16 v[82:83], v14 offset:18432
    v_mfma_f32_16x16x32_bf16 v[52:55], v[92:95], v[108:111], v[52:55]
    ds_read_b64_tr_b16 v[84:85], v15 offset:16384
    ds_read_b64_tr_b16 v[86:87], v15 offset:18432
    v_mfma_f32_16x16x32_bf16 v[56:59], v[96:99], v[108:111], v[56:59]
    v_mfma_f32_16x16x32_bf16 v[60:63], v[100:103], v[108:111], v[60:63]
    s_waitcnt lgkmcnt(0)
    v_mfma_f32_16x16x32_bf16 v[32:35], v[64:67], v[80:83], v[32:35]
    ds_read_b64_tr_b16 v[88:89], v26 offset:8192
    ds_read_b64_tr_b16 v[90:91], v26 offset:12288
    v_mfma_f32_16x16x32_bf16 v[36:39], v[68:71], v[80:83], v[36:39]
    ds_read_b64_tr_b16 v[92:93], v27 offset:8192
    ds_read_b64_tr_b16 v[94:95], v27 offset:12288
    v_mfma_f32_16x16x32_bf16 v[40:43], v[72:75], v[80:83], v[40:43]
    ds_read_b64_tr_b16 v[96:97], v30 offset:8192
    ds_read_b64_tr_b16 v[98:99], v30 offset:12288
    v_mfma_f32_16x16x32_bf16 v[44:47], v[76:79], v[80:83], v[44:47]
    ds_read_b64_tr_b16 v[100:101], v31 offset:8192
    ds_read_b64_tr_b16 v[102:103], v31 offset:12288
    v_mfma_f32_16x16x32_bf16 v[48:51], v[64:67], v[84:87], v[48:51]
    ds_read_b64_tr_b16 v[104:105], v14 offset:20480
    ds_read_b64_tr_b16 v[106:107], v14 offset:22528
    v_mfma_f32_16x16x32_bf16 v[52:55], v[68:71], v[84:87], v[52:55]
    ds_read_b64_tr_b16 v[108:109], v15 offset:20480
    ds_read_b64_tr_b16 v[110:111], v15 offset:22528
    v_mfma_f32_16x16x32_bf16 v[56:59], v[72:75], v[84:87], v[56:59]
    v_mfma_f32_16x16x32_bf16 v[60:63], v[76:79], v[84:87], v[60:63]
    s_waitcnt lgkmcnt(0)
    s_barrier
    v_mfma_f32_16x16x32_bf16 v[32:35], v[88:91], v[104:107], v[32:35]
    ds_read_b64_tr_b16 v[64:65], v26 offset:24576
    ds_read_b64_tr_b16 v[66:67], v26 offset:28672
    v_mfma_f32_16x16x32_bf16 v[36:39], v[92:95], v[104:107], v[36:39]
    ds_read_b64_tr_b16 v[68:69], v27 offset:24576
    ds_read_b64_tr_b16 v[70:71], v27 offset:28672
    v_mfma_f32_16x16x32_bf16 v[40:43], v[96:99], v[104:107], v[40:43]
    ds_read_b64_tr_b16 v[72:73], v30 offset:24576
    ds_read_b64_tr_b16 v[74:75], v30 offset:28672
    v_mfma_f32_16x16x32_bf16 v[44:47], v[100:103], v[104:107], v[44:47]
    ds_read_b64_tr_b16 v[76:77], v31 offset:24576
    ds_read_b64_tr_b16 v[78:79], v31 offset:28672
    v_mfma_f32_16x16x32_bf16 v[48:51], v[88:91], v[108:111], v[48:51]
    ds_read_b64_tr_b16 v[80:81], v14 offset:40960
    ds_read_b64_tr_b16 v[82:83], v14 offset:43008
    v_mfma_f32_16x16x32_bf16 v[52:55], v[92:95], v[108:111], v[52:55]
    ds_read_b64_tr_b16 v[84:85], v15 offset:40960
    ds_read_b64_tr_b16 v[86:87], v15 offset:43008
    v_mfma_f32_16x16x32_bf16 v[56:59], v[96:99], v[108:111], v[56:59]
    v_mfma_f32_16x16x32_bf16 v[60:63], v[100:103], v[108:111], v[60:63]
    s_waitcnt lgkmcnt(0)
    v_mfma_f32_16x16x32_bf16 v[32:35], v[64:67], v[80:83], v[32:35]
    ds_read_b64_tr_b16 v[88:89], v26 offset:32768
    ds_read_b64_tr_b16 v[90:91], v26 offset:36864
    v_mfma_f32_16x16x32_bf16 v[36:39], v[68:71], v[80:83], v[36:39]
    ds_read_b64_tr_b16 v[92:93], v27 offset:32768
    ds_read_b64_tr_b16 v[94:95], v27 offset:36864
    v_mfma_f32_16x16x32_bf16 v[40:43], v[72:75], v[80:83], v[40:43]
    ds_read_b64_tr_b16 v[96:97], v30 offset:32768
    ds_read_b64_tr_b16 v[98:99], v30 offset:36864
    v_mfma_f32_16x16x32_bf16 v[44:47], v[76:79], v[80:83], v[44:47]
    ds_read_b64_tr_b16 v[100:101], v31 offset:32768
    ds_read_b64_tr_b16 v[102:103], v31 offset:36864
    v_mfma_f32_16x16x32_bf16 v[48:51], v[64:67], v[84:87], v[48:51]
    ds_read_b64_tr_b16 v[104:105], v14 offset:45056
    ds_read_b64_tr_b16 v[106:107], v14 offset:47104
    v_mfma_f32_16x16x32_bf16 v[52:55], v[68:71], v[84:87], v[52:55]
    ds_read_b64_tr_b16 v[108:109], v15 offset:45056
    ds_read_b64_tr_b16 v[110:111], v15 offset:47104
    v_mfma_f32_16x16x32_bf16 v[56:59], v[72:75], v[84:87], v[56:59]
    v_mfma_f32_16x16x32_bf16 v[60:63], v[76:79], v[84:87], v[60:63]
    s_waitcnt lgkmcnt(0)
    s_barrier
    v_mfma_f32_16x16x32_bf16 v[32:35], v[88:91], v[104:107], v[32:35]
    ds_read_b64_tr_b16 v[64:65], v16 offset:0
    ds_read_b64_tr_b16 v[66:67], v16 offset:4096
    v_mfma_f32_16x16x32_bf16 v[36:39], v[92:95], v[104:107], v[36:39]
    ds_read_b64_tr_b16 v[68:69], v17 offset:0
    ds_read_b64_tr_b16 v[70:71], v17 offset:4096
    v_mfma_f32_16x16x32_bf16 v[40:43], v[96:99], v[104:107], v[40:43]
    ds_read_b64_tr_b16 v[72:73], v18 offset:0
    ds_read_b64_tr_b16 v[74:75], v18 offset:4096
    v_mfma_f32_16x16x32_bf16 v[44:47], v[100:103], v[104:107], v[44:47]
    ds_read_b64_tr_b16 v[76:77], v19 offset:0
    ds_read_b64_tr_b16 v[78:79], v19 offset:4096
    v_mfma_f32_16x16x32_bf16 v[48:51], v[88:91], v[108:111], v[48:51]
    ds_read_b64_tr_b16 v[80:81], v24 offset:16384
    ds_read_b64_tr_b16 v[82:83], v24 offset:18432
    v_mfma_f32_16x16x32_bf16 v[52:55], v[92:95], v[108:111], v[52:55]
    ds_read_b64_tr_b16 v[84:85], v25 offset:16384
    ds_read_b64_tr_b16 v[86:87], v25 offset:18432
    v_mfma_f32_16x16x32_bf16 v[56:59], v[96:99], v[108:111], v[56:59]
    v_mfma_f32_16x16x32_bf16 v[60:63], v[100:103], v[108:111], v[60:63]
    s_sub_u32 s50, s50, 1
    s_cmp_lg_u32 s50, 0
    s_cbranch_scc1 gemm2_kernel_loop

    s_mov_b32 s24, s10
    s_mov_b32 s25, s11
    s_and_b32 s25, s25, 0xffff
    s_mov_b32 s26, 0x1000
    s_mov_b32 s27, 0x20000
    s_mov_b32 s28, s12
    s_mov_b32 s29, s13
    s_and_b32 s29, s29, 0xffff
    s_mov_b32 s30, 0x400000
    s_mov_b32 s31, 0x20000
    s_add_u32 s52, s4, 0x1400000
    s_addc_u32 s53, s5, 0
    s_and_b32 s53, s53, 0xffff
    s_mov_b32 s54, 0x4000
    s_mov_b32 s55, 0x20000
    s_add_u32 s56, s4, 0x800000
    s_addc_u32 s57, s5, 0
    s_and_b32 s57, s57, 0xffff
    s_mov_b32 s58, 0x400000
    s_mov_b32 s59, 0x20000
    s_mov_b32 s60, s14
    s_mov_b32 s61, s15
    s_and_b32 s61, s61, 0xffff
    s_mov_b32 s62, 0x400000
    s_mov_b32 s63, 0x20000
    s_lshl_b32 s43, s39, 5
    s_add_u32 s43, s43, s36
    v_add_u32 v4, s43, v3
    v_lshlrev_b32 v12, 1, v4
    v_lshlrev_b32 v13, 3, v4
    s_lshl_b32 s44, s38, 6
    s_add_u32 s44, s44, s35
    v_lshl_add_u32 v6, v2, 2, s44
    v_lshlrev_b32 v7, 1, v6
    v_lshl_add_u32 v8, v4, 11, v7
    v_lshl_add_u32 v1, v6, 12, v12
    v_add_u32 v9, 32768, v8

    buffer_load_ushort v10, v12, s[24:27], 0 offen offset:0
    buffer_load_dwordx2 v[4:5], v13, s[52:55], 0 offen offset:0
    buffer_load_dwordx2 v[112:113], v8, s[28:31], 0 offen offset:0
    s_mov_b32 s45, 0
    buffer_load_ushort v128, v1, s[56:59], s45 offen offset:0
    s_mov_b32 s45, 4096
    buffer_load_ushort v129, v1, s[56:59], s45 offen offset:0
    s_mov_b32 s45, 8192
    buffer_load_ushort v130, v1, s[56:59], s45 offen offset:0
    s_mov_b32 s45, 12288
    buffer_load_ushort v131, v1, s[56:59], s45 offen offset:0
    buffer_load_dwordx2 v[114:115], v8, s[28:31], 0 offen offset:32
    s_mov_b32 s45, 65536
    buffer_load_ushort v132, v1, s[56:59], s45 offen offset:0
    s_mov_b32 s45, 69632
    buffer_load_ushort v133, v1, s[56:59], s45 offen offset:0
    s_mov_b32 s45, 73728
    buffer_load_ushort v134, v1, s[56:59], s45 offen offset:0
    s_mov_b32 s45, 77824
    buffer_load_ushort v135, v1, s[56:59], s45 offen offset:0
    buffer_load_dwordx2 v[116:117], v8, s[28:31], 0 offen offset:64
    s_mov_b32 s45, 131072
    buffer_load_ushort v136, v1, s[56:59], s45 offen offset:0
    s_mov_b32 s45, 135168
    buffer_load_ushort v137, v1, s[56:59], s45 offen offset:0
    s_mov_b32 s45, 139264
    buffer_load_ushort v138, v1, s[56:59], s45 offen offset:0
    s_mov_b32 s45, 143360
    buffer_load_ushort v139, v1, s[56:59], s45 offen offset:0
    buffer_load_dwordx2 v[118:119], v8, s[28:31], 0 offen offset:96
    s_mov_b32 s45, 196608
    buffer_load_ushort v140, v1, s[56:59], s45 offen offset:0
    s_mov_b32 s45, 200704
    buffer_load_ushort v141, v1, s[56:59], s45 offen offset:0
    s_mov_b32 s45, 204800
    buffer_load_ushort v142, v1, s[56:59], s45 offen offset:0
    s_mov_b32 s45, 208896
    buffer_load_ushort v143, v1, s[56:59], s45 offen offset:0
    s_waitcnt lgkmcnt(0)
    v_mfma_f32_16x16x32_bf16 v[32:35], v[64:67], v[80:83], v[32:35]
    ds_read_b64_tr_b16 v[88:89], v16 offset:8192
    ds_read_b64_tr_b16 v[90:91], v16 offset:12288
    v_mfma_f32_16x16x32_bf16 v[36:39], v[68:71], v[80:83], v[36:39]
    ds_read_b64_tr_b16 v[92:93], v17 offset:8192
    ds_read_b64_tr_b16 v[94:95], v17 offset:12288
    v_mfma_f32_16x16x32_bf16 v[40:43], v[72:75], v[80:83], v[40:43]
    ds_read_b64_tr_b16 v[96:97], v18 offset:8192
    ds_read_b64_tr_b16 v[98:99], v18 offset:12288
    v_mfma_f32_16x16x32_bf16 v[44:47], v[76:79], v[80:83], v[44:47]
    ds_read_b64_tr_b16 v[100:101], v19 offset:8192
    ds_read_b64_tr_b16 v[102:103], v19 offset:12288
    v_mfma_f32_16x16x32_bf16 v[48:51], v[64:67], v[84:87], v[48:51]
    ds_read_b64_tr_b16 v[104:105], v24 offset:20480
    ds_read_b64_tr_b16 v[106:107], v24 offset:22528
    v_mfma_f32_16x16x32_bf16 v[52:55], v[68:71], v[84:87], v[52:55]
    ds_read_b64_tr_b16 v[108:109], v25 offset:20480
    ds_read_b64_tr_b16 v[110:111], v25 offset:22528
    v_mfma_f32_16x16x32_bf16 v[56:59], v[72:75], v[84:87], v[56:59]
    v_mfma_f32_16x16x32_bf16 v[60:63], v[76:79], v[84:87], v[60:63]
    s_waitcnt lgkmcnt(0)
    s_barrier
    v_mfma_f32_16x16x32_bf16 v[32:35], v[88:91], v[104:107], v[32:35]
    ds_read_b64_tr_b16 v[64:65], v16 offset:24576
    ds_read_b64_tr_b16 v[66:67], v16 offset:28672
    v_mfma_f32_16x16x32_bf16 v[36:39], v[92:95], v[104:107], v[36:39]
    ds_read_b64_tr_b16 v[68:69], v17 offset:24576
    ds_read_b64_tr_b16 v[70:71], v17 offset:28672
    v_mfma_f32_16x16x32_bf16 v[40:43], v[96:99], v[104:107], v[40:43]
    ds_read_b64_tr_b16 v[72:73], v18 offset:24576
    ds_read_b64_tr_b16 v[74:75], v18 offset:28672
    v_mfma_f32_16x16x32_bf16 v[44:47], v[100:103], v[104:107], v[44:47]
    ds_read_b64_tr_b16 v[76:77], v19 offset:24576
    ds_read_b64_tr_b16 v[78:79], v19 offset:28672
    v_mfma_f32_16x16x32_bf16 v[48:51], v[88:91], v[108:111], v[48:51]
    ds_read_b64_tr_b16 v[80:81], v24 offset:40960
    ds_read_b64_tr_b16 v[82:83], v24 offset:43008
    v_mfma_f32_16x16x32_bf16 v[52:55], v[92:95], v[108:111], v[52:55]
    ds_read_b64_tr_b16 v[84:85], v25 offset:40960
    ds_read_b64_tr_b16 v[86:87], v25 offset:43008
    v_mfma_f32_16x16x32_bf16 v[56:59], v[96:99], v[108:111], v[56:59]
    v_mfma_f32_16x16x32_bf16 v[60:63], v[100:103], v[108:111], v[60:63]
    s_waitcnt lgkmcnt(0)
    v_mfma_f32_16x16x32_bf16 v[32:35], v[64:67], v[80:83], v[32:35]
    ds_read_b64_tr_b16 v[88:89], v16 offset:32768
    ds_read_b64_tr_b16 v[90:91], v16 offset:36864
    v_mfma_f32_16x16x32_bf16 v[36:39], v[68:71], v[80:83], v[36:39]
    ds_read_b64_tr_b16 v[92:93], v17 offset:32768
    ds_read_b64_tr_b16 v[94:95], v17 offset:36864
    v_mfma_f32_16x16x32_bf16 v[40:43], v[72:75], v[80:83], v[40:43]
    ds_read_b64_tr_b16 v[96:97], v18 offset:32768
    ds_read_b64_tr_b16 v[98:99], v18 offset:36864
    v_mfma_f32_16x16x32_bf16 v[44:47], v[76:79], v[80:83], v[44:47]
    ds_read_b64_tr_b16 v[100:101], v19 offset:32768
    ds_read_b64_tr_b16 v[102:103], v19 offset:36864
    v_mfma_f32_16x16x32_bf16 v[48:51], v[64:67], v[84:87], v[48:51]
    ds_read_b64_tr_b16 v[104:105], v24 offset:45056
    ds_read_b64_tr_b16 v[106:107], v24 offset:47104
    v_mfma_f32_16x16x32_bf16 v[52:55], v[68:71], v[84:87], v[52:55]
    ds_read_b64_tr_b16 v[108:109], v25 offset:45056
    ds_read_b64_tr_b16 v[110:111], v25 offset:47104
    v_mfma_f32_16x16x32_bf16 v[56:59], v[72:75], v[84:87], v[56:59]
    v_mfma_f32_16x16x32_bf16 v[60:63], v[76:79], v[84:87], v[60:63]
    s_waitcnt lgkmcnt(0)
    s_barrier
    v_mfma_f32_16x16x32_bf16 v[32:35], v[88:91], v[104:107], v[32:35]
    ds_read_b64_tr_b16 v[64:65], v20 offset:0
    ds_read_b64_tr_b16 v[66:67], v20 offset:4096
    v_mfma_f32_16x16x32_bf16 v[36:39], v[92:95], v[104:107], v[36:39]
    ds_read_b64_tr_b16 v[68:69], v21 offset:0
    ds_read_b64_tr_b16 v[70:71], v21 offset:4096
    v_mfma_f32_16x16x32_bf16 v[40:43], v[96:99], v[104:107], v[40:43]
    ds_read_b64_tr_b16 v[72:73], v22 offset:0
    ds_read_b64_tr_b16 v[74:75], v22 offset:4096
    v_mfma_f32_16x16x32_bf16 v[44:47], v[100:103], v[104:107], v[44:47]
    ds_read_b64_tr_b16 v[76:77], v23 offset:0
    ds_read_b64_tr_b16 v[78:79], v23 offset:4096
    v_mfma_f32_16x16x32_bf16 v[48:51], v[88:91], v[108:111], v[48:51]
    ds_read_b64_tr_b16 v[80:81], v28 offset:16384
    ds_read_b64_tr_b16 v[82:83], v28 offset:18432
    v_mfma_f32_16x16x32_bf16 v[52:55], v[92:95], v[108:111], v[52:55]
    ds_read_b64_tr_b16 v[84:85], v29 offset:16384
    ds_read_b64_tr_b16 v[86:87], v29 offset:18432
    v_mfma_f32_16x16x32_bf16 v[56:59], v[96:99], v[108:111], v[56:59]
    v_mfma_f32_16x16x32_bf16 v[60:63], v[100:103], v[108:111], v[60:63]
    s_waitcnt lgkmcnt(0)
    v_mfma_f32_16x16x32_bf16 v[32:35], v[64:67], v[80:83], v[32:35]
    ds_read_b64_tr_b16 v[88:89], v20 offset:8192
    ds_read_b64_tr_b16 v[90:91], v20 offset:12288
    v_mfma_f32_16x16x32_bf16 v[36:39], v[68:71], v[80:83], v[36:39]
    ds_read_b64_tr_b16 v[92:93], v21 offset:8192
    ds_read_b64_tr_b16 v[94:95], v21 offset:12288
    v_mfma_f32_16x16x32_bf16 v[40:43], v[72:75], v[80:83], v[40:43]
    ds_read_b64_tr_b16 v[96:97], v22 offset:8192
    ds_read_b64_tr_b16 v[98:99], v22 offset:12288
    v_mfma_f32_16x16x32_bf16 v[44:47], v[76:79], v[80:83], v[44:47]
    ds_read_b64_tr_b16 v[100:101], v23 offset:8192
    ds_read_b64_tr_b16 v[102:103], v23 offset:12288
    v_mfma_f32_16x16x32_bf16 v[48:51], v[64:67], v[84:87], v[48:51]
    ds_read_b64_tr_b16 v[104:105], v28 offset:20480
    ds_read_b64_tr_b16 v[106:107], v28 offset:22528
    v_mfma_f32_16x16x32_bf16 v[52:55], v[68:71], v[84:87], v[52:55]
    ds_read_b64_tr_b16 v[108:109], v29 offset:20480
    ds_read_b64_tr_b16 v[110:111], v29 offset:22528
    v_mfma_f32_16x16x32_bf16 v[56:59], v[72:75], v[84:87], v[56:59]
    v_mfma_f32_16x16x32_bf16 v[60:63], v[76:79], v[84:87], v[60:63]
    s_waitcnt lgkmcnt(0)
    s_barrier
    v_mfma_f32_16x16x32_bf16 v[32:35], v[88:91], v[104:107], v[32:35]
    ds_read_b64_tr_b16 v[64:65], v20 offset:24576
    ds_read_b64_tr_b16 v[66:67], v20 offset:28672
    v_mfma_f32_16x16x32_bf16 v[36:39], v[92:95], v[104:107], v[36:39]
    ds_read_b64_tr_b16 v[68:69], v21 offset:24576
    ds_read_b64_tr_b16 v[70:71], v21 offset:28672
    v_mfma_f32_16x16x32_bf16 v[40:43], v[96:99], v[104:107], v[40:43]
    ds_read_b64_tr_b16 v[72:73], v22 offset:24576
    ds_read_b64_tr_b16 v[74:75], v22 offset:28672
    v_mfma_f32_16x16x32_bf16 v[44:47], v[100:103], v[104:107], v[44:47]
    ds_read_b64_tr_b16 v[76:77], v23 offset:24576
    ds_read_b64_tr_b16 v[78:79], v23 offset:28672
    v_mfma_f32_16x16x32_bf16 v[48:51], v[88:91], v[108:111], v[48:51]
    ds_read_b64_tr_b16 v[80:81], v28 offset:40960
    ds_read_b64_tr_b16 v[82:83], v28 offset:43008
    v_mfma_f32_16x16x32_bf16 v[52:55], v[92:95], v[108:111], v[52:55]
    ds_read_b64_tr_b16 v[84:85], v29 offset:40960
    ds_read_b64_tr_b16 v[86:87], v29 offset:43008
    v_mfma_f32_16x16x32_bf16 v[56:59], v[96:99], v[108:111], v[56:59]
    v_mfma_f32_16x16x32_bf16 v[60:63], v[100:103], v[108:111], v[60:63]
    s_waitcnt lgkmcnt(0)
    v_mfma_f32_16x16x32_bf16 v[32:35], v[64:67], v[80:83], v[32:35]
    ds_read_b64_tr_b16 v[88:89], v20 offset:32768
    ds_read_b64_tr_b16 v[90:91], v20 offset:36864
    v_mfma_f32_16x16x32_bf16 v[36:39], v[68:71], v[80:83], v[36:39]
    ds_read_b64_tr_b16 v[92:93], v21 offset:32768
    ds_read_b64_tr_b16 v[94:95], v21 offset:36864
    v_mfma_f32_16x16x32_bf16 v[40:43], v[72:75], v[80:83], v[40:43]
    ds_read_b64_tr_b16 v[96:97], v22 offset:32768
    ds_read_b64_tr_b16 v[98:99], v22 offset:36864
    v_mfma_f32_16x16x32_bf16 v[44:47], v[76:79], v[80:83], v[44:47]
    ds_read_b64_tr_b16 v[100:101], v23 offset:32768
    ds_read_b64_tr_b16 v[102:103], v23 offset:36864
    v_mfma_f32_16x16x32_bf16 v[48:51], v[64:67], v[84:87], v[48:51]
    ds_read_b64_tr_b16 v[104:105], v28 offset:45056
    ds_read_b64_tr_b16 v[106:107], v28 offset:47104
    v_mfma_f32_16x16x32_bf16 v[52:55], v[68:71], v[84:87], v[52:55]
    ds_read_b64_tr_b16 v[108:109], v29 offset:45056
    ds_read_b64_tr_b16 v[110:111], v29 offset:47104
    v_mfma_f32_16x16x32_bf16 v[56:59], v[72:75], v[84:87], v[56:59]
    v_mfma_f32_16x16x32_bf16 v[60:63], v[76:79], v[84:87], v[60:63]
    s_waitcnt lgkmcnt(0)
    s_barrier
    v_mfma_f32_16x16x32_bf16 v[32:35], v[88:91], v[104:107], v[32:35]
    ds_read_b64_tr_b16 v[64:65], v26 offset:0
    ds_read_b64_tr_b16 v[66:67], v26 offset:4096
    v_mfma_f32_16x16x32_bf16 v[36:39], v[92:95], v[104:107], v[36:39]
    ds_read_b64_tr_b16 v[68:69], v27 offset:0
    ds_read_b64_tr_b16 v[70:71], v27 offset:4096
    v_mfma_f32_16x16x32_bf16 v[40:43], v[96:99], v[104:107], v[40:43]
    ds_read_b64_tr_b16 v[72:73], v30 offset:0
    ds_read_b64_tr_b16 v[74:75], v30 offset:4096
    v_mfma_f32_16x16x32_bf16 v[44:47], v[100:103], v[104:107], v[44:47]
    ds_read_b64_tr_b16 v[76:77], v31 offset:0
    ds_read_b64_tr_b16 v[78:79], v31 offset:4096
    v_mfma_f32_16x16x32_bf16 v[48:51], v[88:91], v[108:111], v[48:51]
    ds_read_b64_tr_b16 v[80:81], v14 offset:16384
    ds_read_b64_tr_b16 v[82:83], v14 offset:18432
    v_mfma_f32_16x16x32_bf16 v[52:55], v[92:95], v[108:111], v[52:55]
    ds_read_b64_tr_b16 v[84:85], v15 offset:16384
    ds_read_b64_tr_b16 v[86:87], v15 offset:18432
    v_mfma_f32_16x16x32_bf16 v[56:59], v[96:99], v[108:111], v[56:59]
    v_mfma_f32_16x16x32_bf16 v[60:63], v[100:103], v[108:111], v[60:63]
    s_waitcnt lgkmcnt(0)
    v_mfma_f32_16x16x32_bf16 v[32:35], v[64:67], v[80:83], v[32:35]
    ds_read_b64_tr_b16 v[88:89], v26 offset:8192
    ds_read_b64_tr_b16 v[90:91], v26 offset:12288
    v_mfma_f32_16x16x32_bf16 v[36:39], v[68:71], v[80:83], v[36:39]
    ds_read_b64_tr_b16 v[92:93], v27 offset:8192
    ds_read_b64_tr_b16 v[94:95], v27 offset:12288
    v_mfma_f32_16x16x32_bf16 v[40:43], v[72:75], v[80:83], v[40:43]
    ds_read_b64_tr_b16 v[96:97], v30 offset:8192
    ds_read_b64_tr_b16 v[98:99], v30 offset:12288
    v_mfma_f32_16x16x32_bf16 v[44:47], v[76:79], v[80:83], v[44:47]
    ds_read_b64_tr_b16 v[100:101], v31 offset:8192
    ds_read_b64_tr_b16 v[102:103], v31 offset:12288
    v_mfma_f32_16x16x32_bf16 v[48:51], v[64:67], v[84:87], v[48:51]
    ds_read_b64_tr_b16 v[104:105], v14 offset:20480
    ds_read_b64_tr_b16 v[106:107], v14 offset:22528
    v_mfma_f32_16x16x32_bf16 v[52:55], v[68:71], v[84:87], v[52:55]
    ds_read_b64_tr_b16 v[108:109], v15 offset:20480
    ds_read_b64_tr_b16 v[110:111], v15 offset:22528
    v_mfma_f32_16x16x32_bf16 v[56:59], v[72:75], v[84:87], v[56:59]
    v_mfma_f32_16x16x32_bf16 v[60:63], v[76:79], v[84:87], v[60:63]
    s_waitcnt lgkmcnt(0)
    s_barrier
    v_mfma_f32_16x16x32_bf16 v[32:35], v[88:91], v[104:107], v[32:35]
    ds_read_b64_tr_b16 v[64:65], v26 offset:24576
    ds_read_b64_tr_b16 v[66:67], v26 offset:28672
    v_mfma_f32_16x16x32_bf16 v[36:39], v[92:95], v[104:107], v[36:39]
    ds_read_b64_tr_b16 v[68:69], v27 offset:24576
    ds_read_b64_tr_b16 v[70:71], v27 offset:28672
    v_mfma_f32_16x16x32_bf16 v[40:43], v[96:99], v[104:107], v[40:43]
    ds_read_b64_tr_b16 v[72:73], v30 offset:24576
    ds_read_b64_tr_b16 v[74:75], v30 offset:28672
    v_mfma_f32_16x16x32_bf16 v[44:47], v[100:103], v[104:107], v[44:47]
    ds_read_b64_tr_b16 v[76:77], v31 offset:24576
    ds_read_b64_tr_b16 v[78:79], v31 offset:28672
    v_mfma_f32_16x16x32_bf16 v[48:51], v[88:91], v[108:111], v[48:51]
    ds_read_b64_tr_b16 v[80:81], v14 offset:40960
    ds_read_b64_tr_b16 v[82:83], v14 offset:43008
    v_mfma_f32_16x16x32_bf16 v[52:55], v[92:95], v[108:111], v[52:55]
    ds_read_b64_tr_b16 v[84:85], v15 offset:40960
    ds_read_b64_tr_b16 v[86:87], v15 offset:43008
    v_mfma_f32_16x16x32_bf16 v[56:59], v[96:99], v[108:111], v[56:59]
    v_mfma_f32_16x16x32_bf16 v[60:63], v[100:103], v[108:111], v[60:63]
    s_waitcnt lgkmcnt(0)
    v_mfma_f32_16x16x32_bf16 v[32:35], v[64:67], v[80:83], v[32:35]
    ds_read_b64_tr_b16 v[88:89], v26 offset:32768
    ds_read_b64_tr_b16 v[90:91], v26 offset:36864
    v_mfma_f32_16x16x32_bf16 v[36:39], v[68:71], v[80:83], v[36:39]
    ds_read_b64_tr_b16 v[92:93], v27 offset:32768
    ds_read_b64_tr_b16 v[94:95], v27 offset:36864
    v_mfma_f32_16x16x32_bf16 v[40:43], v[72:75], v[80:83], v[40:43]
    ds_read_b64_tr_b16 v[96:97], v30 offset:32768
    ds_read_b64_tr_b16 v[98:99], v30 offset:36864
    v_mfma_f32_16x16x32_bf16 v[44:47], v[76:79], v[80:83], v[44:47]
    ds_read_b64_tr_b16 v[100:101], v31 offset:32768
    ds_read_b64_tr_b16 v[102:103], v31 offset:36864
    v_mfma_f32_16x16x32_bf16 v[48:51], v[64:67], v[84:87], v[48:51]
    ds_read_b64_tr_b16 v[104:105], v14 offset:45056
    ds_read_b64_tr_b16 v[106:107], v14 offset:47104
    v_mfma_f32_16x16x32_bf16 v[52:55], v[68:71], v[84:87], v[52:55]
    ds_read_b64_tr_b16 v[108:109], v15 offset:45056
    ds_read_b64_tr_b16 v[110:111], v15 offset:47104
    v_mfma_f32_16x16x32_bf16 v[56:59], v[72:75], v[84:87], v[56:59]
    v_mfma_f32_16x16x32_bf16 v[60:63], v[76:79], v[84:87], v[60:63]
    s_waitcnt lgkmcnt(0)
    s_barrier
    v_mfma_f32_16x16x32_bf16 v[32:35], v[88:91], v[104:107], v[32:35]
    ds_read_b64_tr_b16 v[64:65], v16 offset:0
    ds_read_b64_tr_b16 v[66:67], v16 offset:4096
    v_mfma_f32_16x16x32_bf16 v[36:39], v[92:95], v[104:107], v[36:39]
    ds_read_b64_tr_b16 v[68:69], v17 offset:0
    ds_read_b64_tr_b16 v[70:71], v17 offset:4096
    v_mfma_f32_16x16x32_bf16 v[40:43], v[96:99], v[104:107], v[40:43]
    ds_read_b64_tr_b16 v[72:73], v18 offset:0
    ds_read_b64_tr_b16 v[74:75], v18 offset:4096
    v_mfma_f32_16x16x32_bf16 v[44:47], v[100:103], v[104:107], v[44:47]
    ds_read_b64_tr_b16 v[76:77], v19 offset:0
    ds_read_b64_tr_b16 v[78:79], v19 offset:4096
    v_mfma_f32_16x16x32_bf16 v[48:51], v[88:91], v[108:111], v[48:51]
    ds_read_b64_tr_b16 v[80:81], v24 offset:16384
    ds_read_b64_tr_b16 v[82:83], v24 offset:18432
    v_mfma_f32_16x16x32_bf16 v[52:55], v[92:95], v[108:111], v[52:55]
    ds_read_b64_tr_b16 v[84:85], v25 offset:16384
    ds_read_b64_tr_b16 v[86:87], v25 offset:18432
    v_mfma_f32_16x16x32_bf16 v[56:59], v[96:99], v[108:111], v[56:59]
    v_mfma_f32_16x16x32_bf16 v[60:63], v[100:103], v[108:111], v[60:63]
    s_waitcnt lgkmcnt(0)
    v_mfma_f32_16x16x32_bf16 v[32:35], v[64:67], v[80:83], v[32:35]
    ds_read_b64_tr_b16 v[88:89], v16 offset:8192
    ds_read_b64_tr_b16 v[90:91], v16 offset:12288
    v_mfma_f32_16x16x32_bf16 v[36:39], v[68:71], v[80:83], v[36:39]
    ds_read_b64_tr_b16 v[92:93], v17 offset:8192
    ds_read_b64_tr_b16 v[94:95], v17 offset:12288
    v_mfma_f32_16x16x32_bf16 v[40:43], v[72:75], v[80:83], v[40:43]
    ds_read_b64_tr_b16 v[96:97], v18 offset:8192
    ds_read_b64_tr_b16 v[98:99], v18 offset:12288
    v_mfma_f32_16x16x32_bf16 v[44:47], v[76:79], v[80:83], v[44:47]
    ds_read_b64_tr_b16 v[100:101], v19 offset:8192
    ds_read_b64_tr_b16 v[102:103], v19 offset:12288
    v_mfma_f32_16x16x32_bf16 v[48:51], v[64:67], v[84:87], v[48:51]
    ds_read_b64_tr_b16 v[104:105], v24 offset:20480
    ds_read_b64_tr_b16 v[106:107], v24 offset:22528
    v_mfma_f32_16x16x32_bf16 v[52:55], v[68:71], v[84:87], v[52:55]
    ds_read_b64_tr_b16 v[108:109], v25 offset:20480
    ds_read_b64_tr_b16 v[110:111], v25 offset:22528
    v_mfma_f32_16x16x32_bf16 v[56:59], v[72:75], v[84:87], v[56:59]
    v_mfma_f32_16x16x32_bf16 v[60:63], v[76:79], v[84:87], v[60:63]
    s_waitcnt lgkmcnt(0)
    s_barrier
    v_mfma_f32_16x16x32_bf16 v[32:35], v[88:91], v[104:107], v[32:35]
    ds_read_b64_tr_b16 v[64:65], v16 offset:24576
    ds_read_b64_tr_b16 v[66:67], v16 offset:28672
    v_mfma_f32_16x16x32_bf16 v[36:39], v[92:95], v[104:107], v[36:39]
    ds_read_b64_tr_b16 v[68:69], v17 offset:24576
    ds_read_b64_tr_b16 v[70:71], v17 offset:28672
    v_mfma_f32_16x16x32_bf16 v[40:43], v[96:99], v[104:107], v[40:43]
    ds_read_b64_tr_b16 v[72:73], v18 offset:24576
    ds_read_b64_tr_b16 v[74:75], v18 offset:28672
    v_mfma_f32_16x16x32_bf16 v[44:47], v[100:103], v[104:107], v[44:47]
    ds_read_b64_tr_b16 v[76:77], v19 offset:24576
    ds_read_b64_tr_b16 v[78:79], v19 offset:28672
    v_mfma_f32_16x16x32_bf16 v[48:51], v[88:91], v[108:111], v[48:51]
    ds_read_b64_tr_b16 v[80:81], v24 offset:40960
    ds_read_b64_tr_b16 v[82:83], v24 offset:43008
    v_mfma_f32_16x16x32_bf16 v[52:55], v[92:95], v[108:111], v[52:55]
    ds_read_b64_tr_b16 v[84:85], v25 offset:40960
    ds_read_b64_tr_b16 v[86:87], v25 offset:43008
    v_mfma_f32_16x16x32_bf16 v[56:59], v[96:99], v[108:111], v[56:59]
    v_mfma_f32_16x16x32_bf16 v[60:63], v[100:103], v[108:111], v[60:63]
    s_waitcnt lgkmcnt(0)
    v_mfma_f32_16x16x32_bf16 v[32:35], v[64:67], v[80:83], v[32:35]
    ds_read_b64_tr_b16 v[88:89], v16 offset:32768
    ds_read_b64_tr_b16 v[90:91], v16 offset:36864
    v_mfma_f32_16x16x32_bf16 v[36:39], v[68:71], v[80:83], v[36:39]
    ds_read_b64_tr_b16 v[92:93], v17 offset:32768
    ds_read_b64_tr_b16 v[94:95], v17 offset:36864
    v_mfma_f32_16x16x32_bf16 v[40:43], v[72:75], v[80:83], v[40:43]
    ds_read_b64_tr_b16 v[96:97], v18 offset:32768
    ds_read_b64_tr_b16 v[98:99], v18 offset:36864
    v_mfma_f32_16x16x32_bf16 v[44:47], v[76:79], v[80:83], v[44:47]
    ds_read_b64_tr_b16 v[100:101], v19 offset:32768
    ds_read_b64_tr_b16 v[102:103], v19 offset:36864
    v_mfma_f32_16x16x32_bf16 v[48:51], v[64:67], v[84:87], v[48:51]
    ds_read_b64_tr_b16 v[104:105], v24 offset:45056
    ds_read_b64_tr_b16 v[106:107], v24 offset:47104
    v_mfma_f32_16x16x32_bf16 v[52:55], v[68:71], v[84:87], v[52:55]
    ds_read_b64_tr_b16 v[108:109], v25 offset:45056
    ds_read_b64_tr_b16 v[110:111], v25 offset:47104
    v_mfma_f32_16x16x32_bf16 v[56:59], v[72:75], v[84:87], v[56:59]
    v_mfma_f32_16x16x32_bf16 v[60:63], v[76:79], v[84:87], v[60:63]
    s_waitcnt lgkmcnt(0)
    v_mfma_f32_16x16x32_bf16 v[32:35], v[88:91], v[104:107], v[32:35]
    v_mfma_f32_16x16x32_bf16 v[36:39], v[92:95], v[104:107], v[36:39]
    v_mfma_f32_16x16x32_bf16 v[40:43], v[96:99], v[104:107], v[40:43]
    v_mfma_f32_16x16x32_bf16 v[44:47], v[100:103], v[104:107], v[44:47]
    v_mfma_f32_16x16x32_bf16 v[48:51], v[88:91], v[108:111], v[48:51]
    v_mfma_f32_16x16x32_bf16 v[52:55], v[92:95], v[108:111], v[52:55]
    v_mfma_f32_16x16x32_bf16 v[56:59], v[96:99], v[108:111], v[56:59]
    v_mfma_f32_16x16x32_bf16 v[60:63], v[100:103], v[108:111], v[60:63]
    s_nop 7
    s_nop 7
    s_mul_i32 s43, s32, 4096
    s_add_u32 s43, s43, 0
    v_lshlrev_b32 v15, 4, v0
    v_add_u32 v15, s43, v15

    ds_write_b128 v15, v[48:51] offset:0
    ds_write_b128 v15, v[52:55] offset:1024
    ds_write_b128 v15, v[56:59] offset:2048
    ds_write_b128 v15, v[60:63] offset:3072
    s_waitcnt lgkmcnt(0)
    s_barrier
    v_mov_b32 v1, 0xffff0000
    s_waitcnt vmcnt(0)

    v_lshlrev_b32 v76, 16, v10
    v_lshlrev_b32 v77, 16, v10
    v_rcp_f32 v82, v5
    v_rcp_f32 v83, v5
    v_mov_b32 v80, v4
    v_mov_b32 v81, v4
    s_nop 0
    v_cvt_pk_bf16_f32 v64, v32, v33
    v_cvt_pk_bf16_f32 v65, v34, v35
    v_lshlrev_b32 v32, 16, v64
    v_lshlrev_b32 v34, 16, v65
    v_and_b32 v33, v1, v64
    v_and_b32 v35, v1, v65
    v_pk_add_f32 v[32:33], v[32:33], v[76:77]
    v_pk_add_f32 v[34:35], v[34:35], v[76:77]
    v_cvt_pk_bf16_f32 v64, v32, v33
    v_cvt_pk_bf16_f32 v65, v34, v35
    v_lshlrev_b32 v32, 16, v64
    v_lshlrev_b32 v34, 16, v65
    v_and_b32 v33, v1, v64
    v_and_b32 v35, v1, v65
    v_lshlrev_b32 v66, 16, v112
    v_lshlrev_b32 v68, 16, v113
    v_and_b32 v67, v1, v112
    v_and_b32 v69, v1, v113
    v_pk_add_f32 v[14:15], v[66:67], v[80:81] neg_lo:[0,1] neg_hi:[0,1]
    v_pk_add_f32 v[16:17], v[68:69], v[80:81] neg_lo:[0,1] neg_hi:[0,1]
    v_cvt_pk_bf16_f32 v64, v14, v15
    v_cvt_pk_bf16_f32 v65, v16, v17
    v_lshlrev_b32 v14, 16, v64
    v_lshlrev_b32 v16, 16, v65
    v_and_b32 v15, v1, v64
    v_and_b32 v17, v1, v65
    v_pk_mul_f32 v[14:15], v[14:15], v[82:83]
    v_pk_mul_f32 v[16:17], v[16:17], v[82:83]
    v_cvt_pk_bf16_f32 v64, v14, v15
    v_cvt_pk_bf16_f32 v65, v16, v17
    v_lshlrev_b32 v14, 16, v64
    v_lshlrev_b32 v16, 16, v65
    v_and_b32 v15, v1, v64
    v_and_b32 v17, v1, v65
    v_lshlrev_b32 v128, 16, v128
    v_lshlrev_b32 v130, 16, v130
    v_lshlrev_b32 v129, 16, v129
    v_lshlrev_b32 v131, 16, v131
    v_pk_mul_f32 v[14:15], v[14:15], v[128:129]
    v_pk_mul_f32 v[16:17], v[16:17], v[130:131]
    v_cvt_pk_bf16_f32 v64, v14, v15
    v_cvt_pk_bf16_f32 v65, v16, v17
    v_lshlrev_b32 v14, 16, v64
    v_lshlrev_b32 v16, 16, v65
    v_and_b32 v15, v1, v64
    v_and_b32 v17, v1, v65
    v_pk_add_f32 v[14:15], v[66:67], v[14:15]
    v_pk_add_f32 v[16:17], v[68:69], v[16:17]
    v_cvt_pk_bf16_f32 v64, v14, v15
    v_cvt_pk_bf16_f32 v65, v16, v17
    v_lshlrev_b32 v14, 16, v64
    v_lshlrev_b32 v16, 16, v65
    v_and_b32 v15, v1, v64
    v_and_b32 v17, v1, v65
    v_pk_add_f32 v[14:15], v[14:15], v[32:33]
    v_pk_add_f32 v[16:17], v[16:17], v[34:35]
    v_cvt_pk_bf16_f32 v72, v14, v15
    v_cvt_pk_bf16_f32 v73, v16, v17
    buffer_store_dwordx2 v[72:73], v8, s[60:63], 0 offen offset:0
    v_cvt_pk_bf16_f32 v64, v36, v37
    v_cvt_pk_bf16_f32 v65, v38, v39
    v_lshlrev_b32 v36, 16, v64
    v_lshlrev_b32 v38, 16, v65
    v_and_b32 v37, v1, v64
    v_and_b32 v39, v1, v65
    v_pk_add_f32 v[36:37], v[36:37], v[76:77]
    v_pk_add_f32 v[38:39], v[38:39], v[76:77]
    v_cvt_pk_bf16_f32 v64, v36, v37
    v_cvt_pk_bf16_f32 v65, v38, v39
    v_lshlrev_b32 v36, 16, v64
    v_lshlrev_b32 v38, 16, v65
    v_and_b32 v37, v1, v64
    v_and_b32 v39, v1, v65
    v_lshlrev_b32 v66, 16, v114
    v_lshlrev_b32 v68, 16, v115
    v_and_b32 v67, v1, v114
    v_and_b32 v69, v1, v115
    v_pk_add_f32 v[14:15], v[66:67], v[80:81] neg_lo:[0,1] neg_hi:[0,1]
    v_pk_add_f32 v[16:17], v[68:69], v[80:81] neg_lo:[0,1] neg_hi:[0,1]
    v_cvt_pk_bf16_f32 v64, v14, v15
    v_cvt_pk_bf16_f32 v65, v16, v17
    v_lshlrev_b32 v14, 16, v64
    v_lshlrev_b32 v16, 16, v65
    v_and_b32 v15, v1, v64
    v_and_b32 v17, v1, v65
    v_pk_mul_f32 v[14:15], v[14:15], v[82:83]
    v_pk_mul_f32 v[16:17], v[16:17], v[82:83]
    v_cvt_pk_bf16_f32 v64, v14, v15
    v_cvt_pk_bf16_f32 v65, v16, v17
    v_lshlrev_b32 v14, 16, v64
    v_lshlrev_b32 v16, 16, v65
    v_and_b32 v15, v1, v64
    v_and_b32 v17, v1, v65
    v_lshlrev_b32 v132, 16, v132
    v_lshlrev_b32 v134, 16, v134
    v_lshlrev_b32 v133, 16, v133
    v_lshlrev_b32 v135, 16, v135
    v_pk_mul_f32 v[14:15], v[14:15], v[132:133]
    v_pk_mul_f32 v[16:17], v[16:17], v[134:135]
    v_cvt_pk_bf16_f32 v64, v14, v15
    v_cvt_pk_bf16_f32 v65, v16, v17
    v_lshlrev_b32 v14, 16, v64
    v_lshlrev_b32 v16, 16, v65
    v_and_b32 v15, v1, v64
    v_and_b32 v17, v1, v65
    v_pk_add_f32 v[14:15], v[66:67], v[14:15]
    v_pk_add_f32 v[16:17], v[68:69], v[16:17]
    v_cvt_pk_bf16_f32 v64, v14, v15
    v_cvt_pk_bf16_f32 v65, v16, v17
    v_lshlrev_b32 v14, 16, v64
    v_lshlrev_b32 v16, 16, v65
    v_and_b32 v15, v1, v64
    v_and_b32 v17, v1, v65
    v_pk_add_f32 v[14:15], v[14:15], v[36:37]
    v_pk_add_f32 v[16:17], v[16:17], v[38:39]
    v_cvt_pk_bf16_f32 v74, v14, v15
    v_cvt_pk_bf16_f32 v75, v16, v17
    buffer_store_dwordx2 v[74:75], v8, s[60:63], 0 offen offset:32
    v_cvt_pk_bf16_f32 v64, v40, v41
    v_cvt_pk_bf16_f32 v65, v42, v43
    v_lshlrev_b32 v40, 16, v64
    v_lshlrev_b32 v42, 16, v65
    v_and_b32 v41, v1, v64
    v_and_b32 v43, v1, v65
    v_pk_add_f32 v[40:41], v[40:41], v[76:77]
    v_pk_add_f32 v[42:43], v[42:43], v[76:77]
    v_cvt_pk_bf16_f32 v64, v40, v41
    v_cvt_pk_bf16_f32 v65, v42, v43
    v_lshlrev_b32 v40, 16, v64
    v_lshlrev_b32 v42, 16, v65
    v_and_b32 v41, v1, v64
    v_and_b32 v43, v1, v65
    v_lshlrev_b32 v66, 16, v116
    v_lshlrev_b32 v68, 16, v117
    v_and_b32 v67, v1, v116
    v_and_b32 v69, v1, v117
    v_pk_add_f32 v[14:15], v[66:67], v[80:81] neg_lo:[0,1] neg_hi:[0,1]
    v_pk_add_f32 v[16:17], v[68:69], v[80:81] neg_lo:[0,1] neg_hi:[0,1]
    v_cvt_pk_bf16_f32 v64, v14, v15
    v_cvt_pk_bf16_f32 v65, v16, v17
    v_lshlrev_b32 v14, 16, v64
    v_lshlrev_b32 v16, 16, v65
    v_and_b32 v15, v1, v64
    v_and_b32 v17, v1, v65
    v_pk_mul_f32 v[14:15], v[14:15], v[82:83]
    v_pk_mul_f32 v[16:17], v[16:17], v[82:83]
    v_cvt_pk_bf16_f32 v64, v14, v15
    v_cvt_pk_bf16_f32 v65, v16, v17
    v_lshlrev_b32 v14, 16, v64
    v_lshlrev_b32 v16, 16, v65
    v_and_b32 v15, v1, v64
    v_and_b32 v17, v1, v65
    v_lshlrev_b32 v136, 16, v136
    v_lshlrev_b32 v138, 16, v138
    v_lshlrev_b32 v137, 16, v137
    v_lshlrev_b32 v139, 16, v139
    v_pk_mul_f32 v[14:15], v[14:15], v[136:137]
    v_pk_mul_f32 v[16:17], v[16:17], v[138:139]
    v_cvt_pk_bf16_f32 v64, v14, v15
    v_cvt_pk_bf16_f32 v65, v16, v17
    v_lshlrev_b32 v14, 16, v64
    v_lshlrev_b32 v16, 16, v65
    v_and_b32 v15, v1, v64
    v_and_b32 v17, v1, v65
    v_pk_add_f32 v[14:15], v[66:67], v[14:15]
    v_pk_add_f32 v[16:17], v[68:69], v[16:17]
    v_cvt_pk_bf16_f32 v64, v14, v15
    v_cvt_pk_bf16_f32 v65, v16, v17
    v_lshlrev_b32 v14, 16, v64
    v_lshlrev_b32 v16, 16, v65
    v_and_b32 v15, v1, v64
    v_and_b32 v17, v1, v65
    v_pk_add_f32 v[14:15], v[14:15], v[40:41]
    v_pk_add_f32 v[16:17], v[16:17], v[42:43]
    v_cvt_pk_bf16_f32 v72, v14, v15
    v_cvt_pk_bf16_f32 v73, v16, v17
    buffer_store_dwordx2 v[72:73], v8, s[60:63], 0 offen offset:64
    v_cvt_pk_bf16_f32 v64, v44, v45
    v_cvt_pk_bf16_f32 v65, v46, v47
    v_lshlrev_b32 v44, 16, v64
    v_lshlrev_b32 v46, 16, v65
    v_and_b32 v45, v1, v64
    v_and_b32 v47, v1, v65
    v_pk_add_f32 v[44:45], v[44:45], v[76:77]
    v_pk_add_f32 v[46:47], v[46:47], v[76:77]
    v_cvt_pk_bf16_f32 v64, v44, v45
    v_cvt_pk_bf16_f32 v65, v46, v47
    v_lshlrev_b32 v44, 16, v64
    v_lshlrev_b32 v46, 16, v65
    v_and_b32 v45, v1, v64
    v_and_b32 v47, v1, v65
    v_lshlrev_b32 v66, 16, v118
    v_lshlrev_b32 v68, 16, v119
    v_and_b32 v67, v1, v118
    v_and_b32 v69, v1, v119
    v_pk_add_f32 v[14:15], v[66:67], v[80:81] neg_lo:[0,1] neg_hi:[0,1]
    v_pk_add_f32 v[16:17], v[68:69], v[80:81] neg_lo:[0,1] neg_hi:[0,1]
    v_cvt_pk_bf16_f32 v64, v14, v15
    v_cvt_pk_bf16_f32 v65, v16, v17
    v_lshlrev_b32 v14, 16, v64
    v_lshlrev_b32 v16, 16, v65
    v_and_b32 v15, v1, v64
    v_and_b32 v17, v1, v65
    v_pk_mul_f32 v[14:15], v[14:15], v[82:83]
    v_pk_mul_f32 v[16:17], v[16:17], v[82:83]
    v_cvt_pk_bf16_f32 v64, v14, v15
    v_cvt_pk_bf16_f32 v65, v16, v17
    v_lshlrev_b32 v14, 16, v64
    v_lshlrev_b32 v16, 16, v65
    v_and_b32 v15, v1, v64
    v_and_b32 v17, v1, v65
    v_lshlrev_b32 v140, 16, v140
    v_lshlrev_b32 v142, 16, v142
    v_lshlrev_b32 v141, 16, v141
    v_lshlrev_b32 v143, 16, v143
    v_pk_mul_f32 v[14:15], v[14:15], v[140:141]
    v_pk_mul_f32 v[16:17], v[16:17], v[142:143]
    v_cvt_pk_bf16_f32 v64, v14, v15
    v_cvt_pk_bf16_f32 v65, v16, v17
    v_lshlrev_b32 v14, 16, v64
    v_lshlrev_b32 v16, 16, v65
    v_and_b32 v15, v1, v64
    v_and_b32 v17, v1, v65
    v_pk_add_f32 v[14:15], v[66:67], v[14:15]
    v_pk_add_f32 v[16:17], v[68:69], v[16:17]
    v_cvt_pk_bf16_f32 v64, v14, v15
    v_cvt_pk_bf16_f32 v65, v16, v17
    v_lshlrev_b32 v14, 16, v64
    v_lshlrev_b32 v16, 16, v65
    v_and_b32 v15, v1, v64
    v_and_b32 v17, v1, v65
    v_pk_add_f32 v[14:15], v[14:15], v[44:45]
    v_pk_add_f32 v[16:17], v[16:17], v[46:47]
    v_cvt_pk_bf16_f32 v74, v14, v15
    v_cvt_pk_bf16_f32 v75, v16, v17
    buffer_store_dwordx2 v[74:75], v8, s[60:63], 0 offen offset:96
gemm2_kernel_done:
    s_endpgm
gemm2_kernel_helper:
gemm2_kernel_hend:
    s_endpgm
gemm2_kernel_conv:
    s_endpgm
.section .rodata,"a"
.p2align 6
.amdhsa_kernel prep_kernel
  .amdhsa_next_free_vgpr 100
  .amdhsa_next_free_sgpr 96
  .amdhsa_accum_offset 100
  .amdhsa_group_segment_fixed_size 0
  .amdhsa_kernarg_size 112
  .amdhsa_user_sgpr_count 2
  .amdhsa_user_sgpr_kernarg_segment_ptr 1
  .amdhsa_system_sgpr_workgroup_id_x 1
.end_amdhsa_kernel
.p2align 6
.amdhsa_kernel gemm1_kernel
  .amdhsa_next_free_vgpr 160
  .amdhsa_next_free_sgpr 96
  .amdhsa_accum_offset 160
  .amdhsa_group_segment_fixed_size 0
  .amdhsa_kernarg_size 112
  .amdhsa_user_sgpr_count 2
  .amdhsa_user_sgpr_kernarg_segment_ptr 1
  .amdhsa_system_sgpr_workgroup_id_x 1
.end_amdhsa_kernel
.p2align 6
.amdhsa_kernel gemm2_kernel
  .amdhsa_next_free_vgpr 160
  .amdhsa_next_free_sgpr 96
  .amdhsa_accum_offset 160
  .amdhsa_group_segment_fixed_size 0
  .amdhsa_kernarg_size 112
  .amdhsa_user_sgpr_count 2
  .amdhsa_user_sgpr_kernarg_segment_ptr 1
  .amdhsa_system_sgpr_workgroup_id_x 1
.end_amdhsa_kernel
```
